```python
import torch

def _softmax(x, axis=-1):
    return torch.softmax(x, dim=axis)
def _gelu(x):
    return torch.nn.functional.gelu(x, approximate="tanh")
def _silu(x):
    return torch.nn.functional.silu(x)
def _sigmoid(x):
    return torch.sigmoid(x)
def _layernorm(x, axis=-1, eps=1e-5):
    m = x.mean(dim=axis, keepdim=True)
    v = x.var(dim=axis, keepdim=True, unbiased=False)
    return (x - m) / torch.sqrt(v + eps)
def _scatter_add(tgt, idx, src, axis=0):
    return tgt.clone().index_add_(axis, idx, src)
def _segment_sum(src, seg, n):
    out = torch.zeros((n,) + src.shape[1:], dtype=src.dtype)
    return out.index_add_(0, seg, src)
def _pad(x, pw):
    flat = tuple(v for pair in reversed(pw) for v in pair)
    return torch.nn.functional.pad(x, flat)

kernel_name = 'standalone__edge_featured_mpnn_egc__graph'

def setup_inputs():

    _w = (lambda a: (lambda t: t.to(torch.bfloat16) if t.is_floating_point() else t)(torch.as_tensor(a)))
    N, deg, D, De = 10000, 16, 128, max(16, 1)
    E = N * deg
    return {
        "x": _w((lambda *s: torch.randn(*s, dtype=torch.bfloat16) * 0.1)(N, D)),
        "e_attr": _w((lambda *s: torch.randn(*s, dtype=torch.bfloat16) * 0.1)(E, De)),
        "src": _w((lambda lo, hi, *s: torch.randint(lo, hi, s))(0, N, E).to(torch.int64)),
        "dst": _w((lambda lo, hi, *s: torch.randint(lo, hi, s))(0, N, E).to(torch.int64)),
        "u_w": _w((lambda *s: torch.randn(*s, dtype=torch.bfloat16) * 0.05)(D, D)),
        "v_w": _w((lambda *s: torch.randn(*s, dtype=torch.bfloat16) * 0.05)(D, D)),
        "g_w": _w((lambda *s: torch.randn(*s, dtype=torch.bfloat16) * 0.1)(2 * D + De, D)),
    }

def reference(x, e_attr, src, dst, u_w, v_w, g_w):
    N, D = x.shape
    g_in = torch.concatenate([x[dst], x[src], e_attr], axis=-1)
    eta = _sigmoid(g_in @ g_w)
    hv = x @ v_w
    msg = eta * hv[src]
    agg = _segment_sum(msg, dst, N)
    return _silu(x @ u_w + agg)
```

```asm
; @launch kernel=prep_kernel grid=(224,1,1) block=(512,1,1) lds=70656
; @launch kernel=standalone__edge_featured_mpnn_egc__graph_kernel grid=(256,1,1) block=(512,1,1) lds=163456
.amdgcn_target "amdgcn-amd-amdhsa--gfx950"
.text
.globl prep_kernel
.p2align 8
.type prep_kernel,@function
prep_kernel:
    s_load_dwordx16 s[4:19], s[0:1], 0
    s_load_dwordx2 s[20:21], s[0:1], 72
    s_cmp_ge_u32 s2, 224
    s_cbranch_scc1 K1_END
    s_cmp_lt_u32 s2, 64
    s_cbranch_scc1 K1_SORT
    s_sub_u32 s3, s2, 64
    s_and_b32 s40, s3, 7
    s_lshr_b32 s41, s3, 4
    s_lshl_b32 s41, s41, 3
    s_add_u32 s40, s40, s41
    s_bfe_u32 s42, s3, 0x10003
    s_mov_b32 s43, 0
    s_cmp_ge_u32 s40, 79
    s_cbranch_scc1 K1_END
    v_and_b32 v1, 7, v0
    v_lshrrev_b32 v2, 3, v0
    v_lshlrev_b32 v3, 8, v2
    v_lshl_add_u32 v3, v1, 4, v3
    v_add_u32 v4, 16384, v3
    v_lshrrev_b32 v5, 6, v0
    s_nop 0
    v_readfirstlane_b32 s48, v5
    v_and_b32 v6, 63, v0
    v_and_b32 v7, 15, v6
    v_lshrrev_b32 v5, 4, v6
    s_lshl_b32 s49, s40, 3
    s_add_u32 s49, s49, s48
    s_lshl_b32 s50, s49, 12
    v_lshlrev_b32 v24, 2, v5
    v_xor_b32 v24, v24, v7
    v_lshlrev_b32 v24, 4, v24
    v_lshl_add_u32 v24, v5, 8, v24
    s_lshl_b32 s51, s48, 12
    s_add_u32 s51, s51, 37888
    s_mov_b32 m0, s51
    s_lshl_b32 s45, s42, 7
    s_waitcnt lgkmcnt(0)
    s_cmp_eq_u32 s43, 0
    s_cselect_b32 s44, 32768, 0
    s_cselect_b32 s46, s14, s12
    s_cselect_b32 s47, s15, s13
    s_add_u32 s28, s16, s44
    s_addc_u32 s29, s17, 0
    s_and_b32 s29, s29, 0xffff
    s_mov_b32 s30, 32768
    s_mov_b32 s31, 0x20000
    s_mov_b32 s32, s46
    s_and_b32 s33, s47, 0xffff
    s_mov_b32 s34, 32768
    s_mov_b32 s35, 0x20000
    s_mov_b32 s36, s4
    s_and_b32 s37, s5, 0xffff
    s_mov_b32 s38, 2560000
    s_mov_b32 s39, 0x20000
    buffer_load_dwordx4 v[8:11], v3, s[28:31], s45 offen
    buffer_load_dwordx4 v[12:15], v4, s[28:31], s45 offen
    buffer_load_dwordx4 v[16:19], v3, s[32:35], s45 offen
    buffer_load_dwordx4 v[20:23], v4, s[32:35], s45 offen
    buffer_load_dwordx4 v24, s[36:39], s50 offen offset:0 lds
    buffer_load_dwordx4 v24, s[36:39], s50 offen offset:1024 lds
    buffer_load_dwordx4 v24, s[36:39], s50 offen offset:2048 lds
    buffer_load_dwordx4 v24, s[36:39], s50 offen offset:3072 lds
    s_mov_b32 s60, s6
    s_and_b32 s61, s7, 0xffff
    s_mov_b32 s62, 5120000
    s_mov_b32 s63, 0x20000
    s_mul_i32 s64, s3, 32768
    v_lshlrev_b32 v108, 6, v0
    buffer_load_dword v109, v108, s[60:63], s64 offen
    v_lshrrev_b32 v25, 4, v2
    v_mul_u32_u24 v25, 4736, v25
    v_and_b32 v26, 15, v2
    v_mul_u32_u24 v26, 288, v26
    v_add_u32 v25, v25, v26
    v_bfe_u32 v26, v2, 3, 1
    v_lshl_add_u32 v25, v26, 7, v25
    v_lshl_add_u32 v25, v1, 4, v25
    v_lshrrev_b32 v26, 1, v5
    v_mul_u32_u24 v26, 4736, v26
    v_and_b32 v27, 1, v5
    v_mul_u32_u24 v27, 2432, v27
    v_add_u32 v26, v26, v27
    v_lshrrev_b32 v27, 2, v7
    v_mul_u32_u24 v27, 288, v27
    v_add_u32 v26, v26, v27
    v_and_b32 v27, 3, v7
    v_lshl_add_u32 v26, v27, 3, v26
    s_mov_b32 s52, 3216550459
    s_mov_b32 s53, 3216550459
    s_mov_b32 s57, 226492416
    s_mov_b32 s58, 0x80008000
    s_mov_b32 s54, 0x07060100
    s_mov_b32 s55, 0x07060302
    s_mov_b32 s59, 0x80000000
    s_lshl_b32 s56, s43, 1
    s_add_u32 s56, s56, s42
    s_mul_i32 s56, s56, 2560000
    s_add_u32 s24, s20, s56
    s_addc_u32 s25, s21, 0
    s_and_b32 s25, s25, 0xffff
    s_mov_b32 s26, 2560000
    s_mov_b32 s27, 0x20000
    v_and_b32 v27, 3, v7
    v_lshlrev_b32 v24, 8, v7
    v_lshl_add_u32 v24, v27, 6, v24
    v_lshl_add_u32 v24, v5, 4, v24
    v_add_u32 v24, s51, v24
    v_xor_b32 v44, 64, v24
    v_xor_b32 v45, 128, v24
    v_xor_b32 v46, 192, v24
    s_waitcnt vmcnt(8)
    ds_write_b128 v25, v[8:11]
    s_waitcnt vmcnt(7)
    ds_write_b128 v25, v[12:15] offset:18944
    s_waitcnt vmcnt(6)
    ds_write_b128 v25, v[16:19] offset:128
    s_waitcnt vmcnt(5)
    ds_write_b128 v25, v[20:23] offset:19072
    s_waitcnt lgkmcnt(0)
    s_barrier
    s_waitcnt vmcnt(1)
    ds_read_b128 v[28:31], v24
    ds_read_b128 v[32:35], v44
    ds_read_b128 v[36:39], v45
    ds_read_b128 v[40:43], v46
    ds_read_b64_tr_b16 v[76:77], v26 offset:0
    ds_read_b64_tr_b16 v[78:79], v26 offset:1152
    ds_read_b64_tr_b16 v[80:81], v26 offset:32
    ds_read_b64_tr_b16 v[82:83], v26 offset:1184
    ds_read_b64_tr_b16 v[84:85], v26 offset:64
    ds_read_b64_tr_b16 v[86:87], v26 offset:1216
    ds_read_b64_tr_b16 v[88:89], v26 offset:96
    ds_read_b64_tr_b16 v[90:91], v26 offset:1248
    ds_read_b64_tr_b16 v[92:93], v26 offset:128
    ds_read_b64_tr_b16 v[94:95], v26 offset:1280
    ds_read_b64_tr_b16 v[96:97], v26 offset:160
    ds_read_b64_tr_b16 v[98:99], v26 offset:1312
    ds_read_b64_tr_b16 v[100:101], v26 offset:192
    ds_read_b64_tr_b16 v[102:103], v26 offset:1344
    ds_read_b64_tr_b16 v[104:105], v26 offset:224
    ds_read_b64_tr_b16 v[106:107], v26 offset:1376
    s_waitcnt lgkmcnt(8)
    v_mfma_f32_16x16x32_bf16 v[44:47], v[28:31], v[76:79], 0
    v_mfma_f32_16x16x32_bf16 v[48:51], v[28:31], v[80:83], 0
    v_mfma_f32_16x16x32_bf16 v[52:55], v[28:31], v[84:87], 0
    v_mfma_f32_16x16x32_bf16 v[56:59], v[28:31], v[88:91], 0
    ds_read_b64_tr_b16 v[76:77], v26 offset:9472
    ds_read_b64_tr_b16 v[78:79], v26 offset:10624
    ds_read_b64_tr_b16 v[80:81], v26 offset:9504
    ds_read_b64_tr_b16 v[82:83], v26 offset:10656
    ds_read_b64_tr_b16 v[84:85], v26 offset:9536
    ds_read_b64_tr_b16 v[86:87], v26 offset:10688
    ds_read_b64_tr_b16 v[88:89], v26 offset:9568
    ds_read_b64_tr_b16 v[90:91], v26 offset:10720
    s_waitcnt lgkmcnt(8)
    v_mfma_f32_16x16x32_bf16 v[60:63], v[28:31], v[92:95], 0
    v_mfma_f32_16x16x32_bf16 v[64:67], v[28:31], v[96:99], 0
    v_mfma_f32_16x16x32_bf16 v[68:71], v[28:31], v[100:103], 0
    v_mfma_f32_16x16x32_bf16 v[72:75], v[28:31], v[104:107], 0
    ds_read_b64_tr_b16 v[92:93], v26 offset:9600
    ds_read_b64_tr_b16 v[94:95], v26 offset:10752
    ds_read_b64_tr_b16 v[96:97], v26 offset:9632
    ds_read_b64_tr_b16 v[98:99], v26 offset:10784
    ds_read_b64_tr_b16 v[100:101], v26 offset:9664
    ds_read_b64_tr_b16 v[102:103], v26 offset:10816
    ds_read_b64_tr_b16 v[104:105], v26 offset:9696
    ds_read_b64_tr_b16 v[106:107], v26 offset:10848
    s_waitcnt lgkmcnt(8)
    v_mfma_f32_16x16x32_bf16 v[44:47], v[32:35], v[76:79], v[44:47]
    v_mfma_f32_16x16x32_bf16 v[48:51], v[32:35], v[80:83], v[48:51]
    v_mfma_f32_16x16x32_bf16 v[52:55], v[32:35], v[84:87], v[52:55]
    v_mfma_f32_16x16x32_bf16 v[56:59], v[32:35], v[88:91], v[56:59]
    ds_read_b64_tr_b16 v[76:77], v26 offset:18944
    ds_read_b64_tr_b16 v[78:79], v26 offset:20096
    ds_read_b64_tr_b16 v[80:81], v26 offset:18976
    ds_read_b64_tr_b16 v[82:83], v26 offset:20128
    ds_read_b64_tr_b16 v[84:85], v26 offset:19008
    ds_read_b64_tr_b16 v[86:87], v26 offset:20160
    ds_read_b64_tr_b16 v[88:89], v26 offset:19040
    ds_read_b64_tr_b16 v[90:91], v26 offset:20192
    s_waitcnt lgkmcnt(8)
    v_mfma_f32_16x16x32_bf16 v[60:63], v[32:35], v[92:95], v[60:63]
    v_mfma_f32_16x16x32_bf16 v[64:67], v[32:35], v[96:99], v[64:67]
    v_mfma_f32_16x16x32_bf16 v[68:71], v[32:35], v[100:103], v[68:71]
    v_mfma_f32_16x16x32_bf16 v[72:75], v[32:35], v[104:107], v[72:75]
    ds_read_b64_tr_b16 v[92:93], v26 offset:19072
    ds_read_b64_tr_b16 v[94:95], v26 offset:20224
    ds_read_b64_tr_b16 v[96:97], v26 offset:19104
    ds_read_b64_tr_b16 v[98:99], v26 offset:20256
    ds_read_b64_tr_b16 v[100:101], v26 offset:19136
    ds_read_b64_tr_b16 v[102:103], v26 offset:20288
    ds_read_b64_tr_b16 v[104:105], v26 offset:19168
    ds_read_b64_tr_b16 v[106:107], v26 offset:20320
    s_waitcnt lgkmcnt(8)
    v_mfma_f32_16x16x32_bf16 v[44:47], v[36:39], v[76:79], v[44:47]
    v_mfma_f32_16x16x32_bf16 v[48:51], v[36:39], v[80:83], v[48:51]
    v_mfma_f32_16x16x32_bf16 v[52:55], v[36:39], v[84:87], v[52:55]
    v_mfma_f32_16x16x32_bf16 v[56:59], v[36:39], v[88:91], v[56:59]
    ds_read_b64_tr_b16 v[76:77], v26 offset:28416
    ds_read_b64_tr_b16 v[78:79], v26 offset:29568
    ds_read_b64_tr_b16 v[80:81], v26 offset:28448
    ds_read_b64_tr_b16 v[82:83], v26 offset:29600
    ds_read_b64_tr_b16 v[84:85], v26 offset:28480
    ds_read_b64_tr_b16 v[86:87], v26 offset:29632
    ds_read_b64_tr_b16 v[88:89], v26 offset:28512
    ds_read_b64_tr_b16 v[90:91], v26 offset:29664
    s_waitcnt lgkmcnt(8)
    v_mfma_f32_16x16x32_bf16 v[60:63], v[36:39], v[92:95], v[60:63]
    v_mfma_f32_16x16x32_bf16 v[64:67], v[36:39], v[96:99], v[64:67]
    v_mfma_f32_16x16x32_bf16 v[68:71], v[36:39], v[100:103], v[68:71]
    v_mfma_f32_16x16x32_bf16 v[72:75], v[36:39], v[104:107], v[72:75]
    ds_read_b64_tr_b16 v[92:93], v26 offset:28544
    ds_read_b64_tr_b16 v[94:95], v26 offset:29696
    ds_read_b64_tr_b16 v[96:97], v26 offset:28576
    ds_read_b64_tr_b16 v[98:99], v26 offset:29728
    ds_read_b64_tr_b16 v[100:101], v26 offset:28608
    ds_read_b64_tr_b16 v[102:103], v26 offset:29760
    ds_read_b64_tr_b16 v[104:105], v26 offset:28640
    ds_read_b64_tr_b16 v[106:107], v26 offset:29792
    s_waitcnt lgkmcnt(8)
    v_mfma_f32_16x16x32_bf16 v[44:47], v[40:43], v[76:79], v[44:47]
    v_mfma_f32_16x16x32_bf16 v[48:51], v[40:43], v[80:83], v[48:51]
    v_mfma_f32_16x16x32_bf16 v[52:55], v[40:43], v[84:87], v[52:55]
    v_mfma_f32_16x16x32_bf16 v[56:59], v[40:43], v[88:91], v[56:59]
    s_waitcnt lgkmcnt(0)
    v_mfma_f32_16x16x32_bf16 v[60:63], v[40:43], v[92:95], v[60:63]
    v_mfma_f32_16x16x32_bf16 v[64:67], v[40:43], v[96:99], v[64:67]
    v_mfma_f32_16x16x32_bf16 v[68:71], v[40:43], v[100:103], v[68:71]
    v_mfma_f32_16x16x32_bf16 v[72:75], v[40:43], v[104:107], v[72:75]
    v_lshlrev_b32 v9, 10, v5
    v_lshl_add_u32 v9, v7, 4, v9
    v_pk_mul_f32 v[44:45], v[44:45], s[52:53]
    v_pk_mul_f32 v[46:47], v[46:47], s[52:53]
    v_pk_mul_f32 v[48:49], v[48:49], s[52:53]
    v_pk_mul_f32 v[50:51], v[50:51], s[52:53]
    v_pk_mul_f32 v[52:53], v[52:53], s[52:53]
    v_pk_mul_f32 v[54:55], v[54:55], s[52:53]
    v_pk_mul_f32 v[56:57], v[56:57], s[52:53]
    v_pk_mul_f32 v[58:59], v[58:59], s[52:53]
    v_cvt_pk_bf16_f32 v16, v44, v48
    v_cvt_pk_bf16_f32 v17, v52, v56
    v_max_f32 v20, |v60|, s57
    v_max_f32 v21, |v64|, s57
    v_max_f32 v22, |v68|, s57
    v_max_f32 v23, |v72|, s57
    v_xor_b32 v18, s58, v16
    v_xor_b32 v19, s58, v17
    v_sub_u32_sdwa v20, v20, sext(v18) dst_sel:DWORD dst_unused:UNUSED_PAD src0_sel:DWORD src1_sel:WORD_0
    v_sub_u32_sdwa v21, v21, sext(v18) dst_sel:DWORD dst_unused:UNUSED_PAD src0_sel:DWORD src1_sel:WORD_1
    v_sub_u32_sdwa v22, v22, sext(v19) dst_sel:DWORD dst_unused:UNUSED_PAD src0_sel:DWORD src1_sel:WORD_0
    v_sub_u32_sdwa v23, v23, sext(v19) dst_sel:DWORD dst_unused:UNUSED_PAD src0_sel:DWORD src1_sel:WORD_1
    v_perm_b32 v12, v20, v16, s54
    v_perm_b32 v13, v21, v16, s55
    v_perm_b32 v14, v22, v17, s54
    v_perm_b32 v15, v23, v17, s55
    v_and_or_b32 v12, v60, s59, v12
    v_and_or_b32 v13, v64, s59, v13
    v_and_or_b32 v14, v68, s59, v14
    v_and_or_b32 v15, v72, s59, v15
    buffer_store_dwordx4 v[12:15], v9, s[24:27], s50 offen offset:0  nt
    v_cvt_pk_bf16_f32 v28, v45, v49
    v_cvt_pk_bf16_f32 v29, v53, v57
    v_max_f32 v32, |v61|, s57
    v_max_f32 v33, |v65|, s57
    v_max_f32 v34, |v69|, s57
    v_max_f32 v35, |v73|, s57
    v_xor_b32 v30, s58, v28
    v_xor_b32 v31, s58, v29
    v_sub_u32_sdwa v32, v32, sext(v30) dst_sel:DWORD dst_unused:UNUSED_PAD src0_sel:DWORD src1_sel:WORD_0
    v_sub_u32_sdwa v33, v33, sext(v30) dst_sel:DWORD dst_unused:UNUSED_PAD src0_sel:DWORD src1_sel:WORD_1
    v_sub_u32_sdwa v34, v34, sext(v31) dst_sel:DWORD dst_unused:UNUSED_PAD src0_sel:DWORD src1_sel:WORD_0
    v_sub_u32_sdwa v35, v35, sext(v31) dst_sel:DWORD dst_unused:UNUSED_PAD src0_sel:DWORD src1_sel:WORD_1
    v_perm_b32 v24, v32, v28, s54
    v_perm_b32 v25, v33, v28, s55
    v_perm_b32 v26, v34, v29, s54
    v_perm_b32 v27, v35, v29, s55
    v_and_or_b32 v24, v61, s59, v24
    v_and_or_b32 v25, v65, s59, v25
    v_and_or_b32 v26, v69, s59, v26
    v_and_or_b32 v27, v73, s59, v27
    buffer_store_dwordx4 v[24:27], v9, s[24:27], s50 offen offset:256  nt
    v_cvt_pk_bf16_f32 v16, v46, v50
    v_cvt_pk_bf16_f32 v17, v54, v58
    v_max_f32 v20, |v62|, s57
    v_max_f32 v21, |v66|, s57
    v_max_f32 v22, |v70|, s57
    v_max_f32 v23, |v74|, s57
    v_xor_b32 v18, s58, v16
    v_xor_b32 v19, s58, v17
    v_sub_u32_sdwa v20, v20, sext(v18) dst_sel:DWORD dst_unused:UNUSED_PAD src0_sel:DWORD src1_sel:WORD_0
    v_sub_u32_sdwa v21, v21, sext(v18) dst_sel:DWORD dst_unused:UNUSED_PAD src0_sel:DWORD src1_sel:WORD_1
    v_sub_u32_sdwa v22, v22, sext(v19) dst_sel:DWORD dst_unused:UNUSED_PAD src0_sel:DWORD src1_sel:WORD_0
    v_sub_u32_sdwa v23, v23, sext(v19) dst_sel:DWORD dst_unused:UNUSED_PAD src0_sel:DWORD src1_sel:WORD_1
    v_perm_b32 v12, v20, v16, s54
    v_perm_b32 v13, v21, v16, s55
    v_perm_b32 v14, v22, v17, s54
    v_perm_b32 v15, v23, v17, s55
    v_and_or_b32 v12, v62, s59, v12
    v_and_or_b32 v13, v66, s59, v13
    v_and_or_b32 v14, v70, s59, v14
    v_and_or_b32 v15, v74, s59, v15
    buffer_store_dwordx4 v[12:15], v9, s[24:27], s50 offen offset:512  nt
    v_cvt_pk_bf16_f32 v28, v47, v51
    v_cvt_pk_bf16_f32 v29, v55, v59
    v_max_f32 v32, |v63|, s57
    v_max_f32 v33, |v67|, s57
    v_max_f32 v34, |v71|, s57
    v_max_f32 v35, |v75|, s57
    v_xor_b32 v30, s58, v28
    v_xor_b32 v31, s58, v29
    v_sub_u32_sdwa v32, v32, sext(v30) dst_sel:DWORD dst_unused:UNUSED_PAD src0_sel:DWORD src1_sel:WORD_0
    v_sub_u32_sdwa v33, v33, sext(v30) dst_sel:DWORD dst_unused:UNUSED_PAD src0_sel:DWORD src1_sel:WORD_1
    v_sub_u32_sdwa v34, v34, sext(v31) dst_sel:DWORD dst_unused:UNUSED_PAD src0_sel:DWORD src1_sel:WORD_0
    v_sub_u32_sdwa v35, v35, sext(v31) dst_sel:DWORD dst_unused:UNUSED_PAD src0_sel:DWORD src1_sel:WORD_1
    v_perm_b32 v24, v32, v28, s54
    v_perm_b32 v25, v33, v28, s55
    v_perm_b32 v26, v34, v29, s54
    v_perm_b32 v27, v35, v29, s55
    v_and_or_b32 v24, v63, s59, v24
    v_and_or_b32 v25, v67, s59, v25
    v_and_or_b32 v26, v71, s59, v26
    v_and_or_b32 v27, v75, s59, v27
    buffer_store_dwordx4 v[24:27], v9, s[24:27], s50 offen offset:768  nt
    s_endpgm
K1_SORT:
    s_mul_i32 s40, s2, 10000
    v_mul_u32_u24 v1, 20, v0
    v_mov_b32 v20, 0
    v_mov_b32 v21, 0
    v_lshlrev_b32 v2, 3, v0
    ds_write_b64 v2, v[20:21] offset:0
    s_waitcnt lgkmcnt(0)
    s_mov_b32 s28, s10
    s_and_b32 s29, s11, 0xffff
    s_mov_b32 s30, 640000
    s_mov_b32 s31, 0x20000
    s_mov_b32 s32, s8
    s_and_b32 s33, s9, 0xffff
    s_mov_b32 s34, 640000
    s_mov_b32 s35, 0x20000
    s_mov_b32 s24, s20
    s_and_b32 s25, s21, 0xffff
    s_mov_b32 s26, 14336000
    s_mov_b32 s27, 0x20000
    buffer_load_dwordx4 v[8:11], v1, s[28:31], s40 offen
    buffer_load_dword v12, v1, s[28:31], s40 offen offset:16
    buffer_load_dwordx4 v[14:17], v1, s[32:35], s40 offen
    buffer_load_dword v18, v1, s[32:35], s40 offen offset:16
    v_mov_b32 v3, 1
    v_mul_u32_u24 v4, 80, v0
    s_barrier
    v_cmp_gt_u32 vcc, 500, v0
    s_and_saveexec_b64 s[42:43], vcc
    s_waitcnt vmcnt(2)
    v_mul_u32_u24 v24, 52429, v8
    v_lshrrev_b32 v24, 19, v24
    v_lshlrev_b32 v30, 2, v24
    ds_add_rtn_u32 v36, v30, v3
    v_mul_u32_u24 v25, 52429, v9
    v_lshrrev_b32 v25, 19, v25
    v_lshlrev_b32 v31, 2, v25
    ds_add_rtn_u32 v37, v31, v3
    v_mul_u32_u24 v26, 52429, v10
    v_lshrrev_b32 v26, 19, v26
    v_lshlrev_b32 v32, 2, v26
    ds_add_rtn_u32 v38, v32, v3
    v_mul_u32_u24 v27, 52429, v11
    v_lshrrev_b32 v27, 19, v27
    v_lshlrev_b32 v33, 2, v27
    ds_add_rtn_u32 v39, v33, v3
    v_mul_u32_u24 v28, 52429, v12
    v_lshrrev_b32 v28, 19, v28
    v_lshlrev_b32 v34, 2, v28
    ds_add_rtn_u32 v40, v34, v3
    s_waitcnt vmcnt(0)
    v_mul_u32_u24 v30, 10, v24
    v_sub_u32 v8, v8, v30
    v_lshl_or_b32 v8, v14, 16, v8
    v_add3_u32 v8, v8, v4, 0
    v_lshlrev_b32 v24, 6, v24
    v_mul_u32_u24 v31, 10, v25
    v_sub_u32 v9, v9, v31
    v_lshl_or_b32 v9, v15, 16, v9
    v_add3_u32 v9, v9, v4, 16
    v_lshlrev_b32 v25, 6, v25
    v_mul_u32_u24 v32, 10, v26
    v_sub_u32 v10, v10, v32
    v_lshl_or_b32 v10, v16, 16, v10
    v_add3_u32 v10, v10, v4, 32
    v_lshlrev_b32 v26, 6, v26
    v_mul_u32_u24 v33, 10, v27
    v_sub_u32 v11, v11, v33
    v_lshl_or_b32 v11, v17, 16, v11
    v_add3_u32 v11, v11, v4, 48
    v_lshlrev_b32 v27, 6, v27
    v_mul_u32_u24 v34, 10, v28
    v_sub_u32 v12, v12, v34
    v_lshl_or_b32 v12, v18, 16, v12
    v_add3_u32 v12, v12, v4, 64
    v_lshlrev_b32 v28, 6, v28
    s_waitcnt lgkmcnt(4)
    v_min_u32 v36, 14, v36
    v_lshl_add_u32 v36, v36, 2, v24
    ds_write_b32 v36, v8 offset:4100
    s_waitcnt lgkmcnt(4)
    v_min_u32 v37, 14, v37
    v_lshl_add_u32 v37, v37, 2, v25
    ds_write_b32 v37, v9 offset:4100
    s_waitcnt lgkmcnt(4)
    v_min_u32 v38, 14, v38
    v_lshl_add_u32 v38, v38, 2, v26
    ds_write_b32 v38, v10 offset:4100
    s_waitcnt lgkmcnt(4)
    v_min_u32 v39, 14, v39
    v_lshl_add_u32 v39, v39, 2, v27
    ds_write_b32 v39, v11 offset:4100
    s_waitcnt lgkmcnt(4)
    v_min_u32 v40, 14, v40
    v_lshl_add_u32 v40, v40, 2, v28
    ds_write_b32 v40, v12 offset:4100
    s_mov_b64 exec, s[42:43]
    v_lshlrev_b32 v1, 6, v0
    v_lshlrev_b32 v6, 2, v0
    v_lshlrev_b32 v7, 12, v0
    s_and_b32 s44, s2, 7
    s_lshl_b32 s44, s44, 3
    s_lshr_b32 s45, s2, 3
    s_add_u32 s44, s44, s45
    s_lshl_b32 s44, s44, 4
    s_add_u32 s44, s44, 10240000
    s_add_u32 s45, s44, 2097152
    s_waitcnt lgkmcnt(0)
    s_barrier
    ds_read_b32 v60, v6 offset:0
    ds_read_b128 v[40:43], v1 offset:4096
    ds_read_b128 v[44:47], v1 offset:4112
    ds_read_b32 v61, v6 offset:2048
    ds_read_b128 v[48:51], v1 offset:36864
    ds_read_b128 v[52:55], v1 offset:36880
    s_waitcnt lgkmcnt(3)
    v_mov_b32 v40, v60
    v_cmp_lt_u32 vcc, 3, v60
    buffer_store_dwordx4 v[40:43], v7, s[24:27], s44 offen
    s_mov_b64 exec, vcc
    buffer_store_dwordx4 v[44:47], v7, s[24:27], s44 offen offset:1024
    s_mov_b64 exec, -1
    s_waitcnt lgkmcnt(0)
    v_mov_b32 v48, v61
    v_cmp_lt_u32 vcc, 3, v61
    buffer_store_dwordx4 v[48:51], v7, s[24:27], s45 offen
    s_mov_b64 exec, vcc
    buffer_store_dwordx4 v[52:55], v7, s[24:27], s45 offen offset:1024
    s_mov_b64 exec, -1
    v_cmp_lt_u32 vcc, 7, v60
    s_and_saveexec_b64 s[42:43], vcc
    s_cbranch_execz K1_SK0
    ds_read_b128 v[24:27], v1 offset:4128
    ds_read_b128 v[28:31], v1 offset:4144
    s_waitcnt lgkmcnt(0)
    buffer_store_dwordx4 v[24:27], v7, s[24:27], s44 offen offset:2048
    buffer_store_dwordx4 v[28:31], v7, s[24:27], s44 offen offset:3072
K1_SK0:
    s_mov_b64 exec, s[42:43]
    v_cmp_lt_u32 vcc, 7, v61
    s_and_saveexec_b64 s[42:43], vcc
    s_cbranch_execz K1_SK1
    ds_read_b128 v[32:35], v1 offset:36896
    ds_read_b128 v[36:39], v1 offset:36912
    s_waitcnt lgkmcnt(0)
    buffer_store_dwordx4 v[32:35], v7, s[24:27], s45 offen offset:2048
    buffer_store_dwordx4 v[36:39], v7, s[24:27], s45 offen offset:3072
K1_SK1:
    s_mov_b64 exec, s[42:43]
    s_endpgm
K1_CT:
    v_and_b32 v1, 15, v0
    v_bfe_u32 v2, v0, 4, 2
    v_lshrrev_b32 v3, 6, v0
    v_lshl_add_u32 v1, v3, 4, v1
    v_lshlrev_b32 v1, 1, v1
    v_lshl_add_u32 v1, v2, 10, v1
    v_lshlrev_b32 v2, 3, v0
    s_mov_b32 s52, 3216550459
    s_waitcnt lgkmcnt(0)
    s_add_u32 s28, s16, 65536
    s_addc_u32 s29, s17, 0
    s_and_b32 s29, s29, 0xffff
    s_mov_b32 s30, 4096
    s_mov_b32 s31, 0x20000
    s_add_u32 s24, s20, 14467072
    s_addc_u32 s25, s21, 0
    s_and_b32 s25, s25, 0xffff
    s_mov_b32 s26, 4096
    s_mov_b32 s27, 0x20000
    buffer_load_ushort v4, v1, s[28:31], 0 offen offset:0
    buffer_load_ushort v5, v1, s[28:31], 0 offen offset:256
    buffer_load_ushort v6, v1, s[28:31], 0 offen offset:512
    buffer_load_ushort v7, v1, s[28:31], 0 offen offset:768
    s_waitcnt vmcnt(0)
    v_lshlrev_b32 v4, 16, v4
    v_mul_f32 v4, s52, v4
    v_lshlrev_b32 v5, 16, v5
    v_mul_f32 v5, s52, v5
    v_lshlrev_b32 v6, 16, v6
    v_mul_f32 v6, s52, v6
    v_lshlrev_b32 v7, 16, v7
    v_mul_f32 v7, s52, v7
    v_cvt_pk_bf16_f32 v8, v4, v5
    v_cvt_pk_bf16_f32 v9, v6, v7
    buffer_store_dwordx2 v[8:9], v2, s[24:27], 0 offen
K1_END:
    s_endpgm
.globl standalone__edge_featured_mpnn_egc__graph_kernel
.p2align 8
.type standalone__edge_featured_mpnn_egc__graph_kernel,@function
standalone__edge_featured_mpnn_egc__graph_kernel:
    s_load_dwordx16 s[4:19], s[0:1], 0
    s_load_dwordx2 s[20:21], s[0:1], 72
    s_setprio 3
    s_lshr_b32 s40, s2, 3
    s_lshl_b32 s40, s40, 2
    s_and_b32 s41, s2, 3
    s_add_u32 s40, s40, s41
    s_bfe_u32 s41, s2, 0x10002
    s_cmp_ge_u32 s40, 125
    s_cbranch_scc1 K2_END
    v_lshrrev_b32 v7, 6, v0
    s_nop 0
    v_readfirstlane_b32 s42, v7
    v_and_b32 v7, 63, v0
    s_mul_i32 s46, s40, 80
    s_lshl_b32 s40, s40, 3
    s_add_u32 s40, s40, s42
    s_lshl_b32 s43, s40, 12
    s_add_u32 s43, s43, 10240000
    v_lshlrev_b32 v15, 4, v7
    v_and_b32 v52, 7, v0
    v_lshrrev_b32 v53, 3, v0
    v_lshlrev_b32 v54, 8, v53
    v_lshl_add_u32 v54, v52, 4, v54
    v_and_b32 v1, 15, v7
    v_lshrrev_b32 v55, 4, v7
    s_mul_i32 s47, s42, 12
    s_add_u32 s46, s46, s47
    v_lshlrev_b32 v235, 2, v55
    v_xor_b32 v235, v235, v1
    v_lshlrev_b32 v235, 4, v235
    v_add3_u32 v232, v55, s46, 0
    v_min_u32 v232, 9999, v232
    v_lshl_add_u32 v232, v232, 8, v235
    v_add3_u32 v233, v55, s46, 4
    v_min_u32 v233, 9999, v233
    v_lshl_add_u32 v233, v233, 8, v235
    v_add3_u32 v234, v55, s46, 8
    v_min_u32 v234, 9999, v234
    v_lshl_add_u32 v234, v234, 8, v235
    s_lshl_b32 s45, s41, 7
    s_mul_i32 s48, s42, 12288
    s_mul_i32 s36, s42, 3072
    s_add_u32 s36, s36, 98304
    s_waitcnt lgkmcnt(0)
    s_mov_b32 s24, s20
    s_and_b32 s25, s21, 0xffff
    s_mov_b32 s26, 14336000
    s_mov_b32 s27, 0x20000
    buffer_load_dwordx4 v[136:139], v15, s[24:27], s43 offen offset:0
    buffer_load_dwordx4 v[140:143], v15, s[24:27], s43 offen offset:1024
    s_mov_b32 s64, s16
    s_and_b32 s65, s17, 0xffff
    s_mov_b32 s66, 69632
    s_mov_b32 s67, 0x20000
    s_mov_b32 s68, s12
    s_and_b32 s69, s13, 0xffff
    s_mov_b32 s70, 32768
    s_mov_b32 s71, 0x20000
    s_mov_b32 s72, s4
    s_and_b32 s73, s5, 0xffff
    s_mov_b32 s74, 2560000
    s_mov_b32 s75, 0x20000
    s_mul_i32 s46, s41, 2560000
    s_add_u32 s28, s20, s46
    s_addc_u32 s29, s21, 0
    s_and_b32 s29, s29, 0xffff
    s_mov_b32 s30, 2560000
    s_mov_b32 s31, 0x20000
    s_mov_b32 s32, s6
    s_and_b32 s33, s7, 0xffff
    s_or_b32 s33, s33, 0x200000
    s_mov_b32 s34, 160000
    s_mov_b32 s35, 0x20000
    v_lshrrev_b32 v4, 2, v7
    v_and_b32 v6, 3, v7
    v_lshlrev_b32 v5, 2, v6
    v_sub_u32 v5, v4, v5
    v_lshlrev_b32 v2, 4, v5
    v_mov_b32 v8, 0x3f80
    v_mov_b32 v9, 0
    v_lshlrev_b64 v[8:9], v2, v[8:9]
    v_cmp_gt_u32 vcc, 4, v5
    s_nop 1
    v_cndmask_b32 v8, 0, v8, vcc
    v_cndmask_b32 v9, 0, v9, vcc
    v_lshl_add_u32 v2, v7, 3, s48
    ds_write_b64 v2, v[8:9]
    s_cmp_ge_u32 s42, 2
    s_cbranch_scc1 K2_NOC0
    s_add_u32 s47, s45, 65536
    buffer_load_dwordx4 v[88:91], v54, s[64:67], s47 offen
K2_NOC0:
    s_add_u32 s47, s45, 16384
    s_mov_b32 m0, s36
    buffer_load_dwordx4 v[56:59], v54, s[64:67], s45 offen
    buffer_load_dwordx4 v[60:63], v54, s[68:71], s45 offen
    buffer_load_dwordx4 v[64:67], v54, s[64:67], s47 offen
    buffer_load_dwordx4 v[68:71], v54, s[68:71], s47 offen
    buffer_load_dwordx4 v232, s[72:75], 0 offen  lds
    s_add_u32 m0, m0, 1024
    s_nop 0
    buffer_load_dwordx4 v233, s[72:75], 0 offen  lds
    s_add_u32 m0, m0, 1024
    s_nop 0
    buffer_load_dwordx4 v234, s[72:75], 0 offen  lds
    v_lshl_add_u32 v12, v55, 4, s48
    v_add_u32 v12, 512, v12
    v_lshl_add_u32 v13, v1, 2, s48
    v_add_u32 v13, 4864, v13
    v_lshl_add_u32 v14, v4, 2, s48
    v_add_u32 v14, 4864, v14
    v_lshl_add_u32 v5, v55, 3, s48
    v_lshl_add_u32 v11, v1, 5, v5
    v_lshl_add_u32 v6, v6, 3, s48
    v_and_b32 v9, 1, v7
    v_lshlrev_b32 v9, 4, v9
    v_lshrrev_b32 v54, 4, v53
    v_mul_u32_u24 v54, 4736, v54
    v_and_b32 v15, 15, v53
    v_mul_u32_u24 v15, 288, v15
    v_add_u32 v54, v54, v15
    v_bfe_u32 v15, v53, 3, 1
    v_lshl_add_u32 v54, v15, 7, v54
    v_lshl_add_u32 v54, v52, 4, v54
    v_mul_u32_u24 v53, 160, v53
    v_lshl_add_u32 v53, v52, 4, v53
    v_lshrrev_b32 v52, 1, v55
    v_mul_u32_u24 v52, 4736, v52
    v_and_b32 v15, 1, v55
    v_mul_u32_u24 v15, 2432, v15
    v_add_u32 v52, v52, v15
    v_lshrrev_b32 v15, 2, v1
    v_mul_u32_u24 v15, 288, v15
    v_add_u32 v52, v52, v15
    v_and_b32 v15, 3, v1
    v_lshl_add_u32 v52, v15, 3, v52
    s_mul_i32 s47, s42, 10
    v_add_u32 v236, s47, v1
    v_and_b32 v15, 3, v236
    v_lshlrev_b32 v236, 8, v236
    v_lshl_add_u32 v236, v15, 6, v236
    v_lshl_add_u32 v236, v55, 4, v236
    v_add_u32 v236, 98304, v236
    v_xor_b32 v237, 64, v236
    v_xor_b32 v238, 128, v236
    v_xor_b32 v239, 192, v236
    v_mul_u32_u24 v55, 160, v4
    v_and_b32 v15, 3, v7
    v_lshl_add_u32 v55, v15, 3, v55
    v_add_u32 v53, 160768, v53
    v_add_u32 v55, 160768, v55
    v_add_u32 v52, 122880, v52
    v_add_u32 v54, 122880, v54
    v_lshrrev_b32 v15, 1, v7
    v_lshl_add_u32 v15, v15, 2, s48
    v_add_u32 v15, 4864, v15
    v_lshlrev_b32 v1, 4, v1
    v_and_b32 v120, 7, v7
    v_lshrrev_b32 v121, 3, v7
    v_lshl_add_u32 v120, v120, 3, v121
    v_mul_u32_u24 v120, 1280000, v120
    s_mov_b32 s53, 3216550459
    s_mov_b32 s52, 3216550459
    s_mov_b32 s54, 1.0
    s_mov_b32 s55, 1.0
    s_mov_b32 s62, 5
    s_mov_b32 s50, 0x0c070600
    s_mov_b32 s51, 0x1e0
    s_mov_b32 s49, 0
    s_add_u32 s36, s48, 9216
    s_add_u32 s37, s48, 10240
    s_add_u32 s38, s48, 11264
    s_waitcnt vmcnt(7)
    v_cmp_lt_u32 s[56:57], 15, v136
    s_nop 1
    v_cndmask_b32 v136, v136, 0, s[56:57]
    v_mov_b32 v152, v136
    s_nop 1
    v_add_u32_dpp v152, v152, v152 row_shr:1 row_mask:0xf bank_mask:0xf bound_ctrl:0
    s_nop 1
    v_add_u32_dpp v152, v152, v152 row_shr:2 row_mask:0xf bank_mask:0xf bound_ctrl:0
    s_nop 1
    v_add_u32_dpp v152, v152, v152 row_shr:4 row_mask:0xf bank_mask:0xf bound_ctrl:0
    s_nop 1
    v_add_u32_dpp v152, v152, v152 row_shr:8 row_mask:0xf bank_mask:0xf bound_ctrl:0
    s_nop 1
    v_add_u32_dpp v152, v152, v152 row_bcast:15 row_mask:0xa bank_mask:0xf
    s_nop 1
    v_add_u32_dpp v152, v152, v152 row_bcast:31 row_mask:0xc bank_mask:0xf
    s_nop 0
    v_readlane_b32 s58, v152, 63
    v_sub_u32 v152, v152, v136
    v_lshl_add_u32 v152, v152, 2, s48
    v_cmpx_lt_u32 vcc, 0, v136
    v_mad_u32_u16 v153, v137, 32, v120
    ds_write_b32 v152, v137 offset:512
    ds_write_b32 v152, v153 offset:4864
    v_cmpx_lt_u32 vcc, 1, v136
    v_mad_u32_u16 v154, v138, 32, v120
    ds_write_b32 v152, v138 offset:516
    ds_write_b32 v152, v154 offset:4868
    v_cmpx_lt_u32 vcc, 2, v136
    v_mad_u32_u16 v153, v139, 32, v120
    ds_write_b32 v152, v139 offset:520
    ds_write_b32 v152, v153 offset:4872
    v_cmpx_lt_u32 vcc, 3, v136
    v_mad_u32_u16 v154, v140, 32, v120
    ds_write_b32 v152, v140 offset:524
    ds_write_b32 v152, v154 offset:4876
    v_cmpx_lt_u32 vcc, 4, v136
    s_cbranch_execz K2_CDONE
    v_mad_u32_u16 v153, v141, 32, v120
    ds_write_b32 v152, v141 offset:528
    ds_write_b32 v152, v153 offset:4880
    v_cmpx_lt_u32 vcc, 5, v136
    s_cbranch_execz K2_CDONE
    v_mad_u32_u16 v154, v142, 32, v120
    ds_write_b32 v152, v142 offset:532
    ds_write_b32 v152, v154 offset:4884
    v_cmpx_lt_u32 vcc, 6, v136
    s_cbranch_execz K2_CDONE
    v_mad_u32_u16 v153, v143, 32, v120
    ds_write_b32 v152, v143 offset:536
    ds_write_b32 v152, v153 offset:4888
    v_cmpx_lt_u32 vcc, 7, v136
    s_cbranch_execz K2_CDONE
    v_lshlrev_b32 v155, 4, v7
    buffer_load_dwordx4 v[144:147], v155, s[24:27], s43 offen offset:2048
    buffer_load_dwordx4 v[148:151], v155, s[24:27], s43 offen offset:3072
    s_waitcnt vmcnt(0)
    v_mad_u32_u16 v154, v144, 32, v120
    ds_write_b32 v152, v144 offset:540
    ds_write_b32 v152, v154 offset:4892
    v_cmpx_lt_u32 vcc, 8, v136
    s_cbranch_execz K2_CDONE
    v_mad_u32_u16 v153, v145, 32, v120
    ds_write_b32 v152, v145 offset:544
    ds_write_b32 v152, v153 offset:4896
    v_cmpx_lt_u32 vcc, 9, v136
    s_cbranch_execz K2_CDONE
    v_mad_u32_u16 v154, v146, 32, v120
    ds_write_b32 v152, v146 offset:548
    ds_write_b32 v152, v154 offset:4900
    v_cmpx_lt_u32 vcc, 10, v136
    s_cbranch_execz K2_CDONE
    v_mad_u32_u16 v153, v147, 32, v120
    ds_write_b32 v152, v147 offset:552
    ds_write_b32 v152, v153 offset:4904
    v_cmpx_lt_u32 vcc, 11, v136
    s_cbranch_execz K2_CDONE
    v_mad_u32_u16 v154, v148, 32, v120
    ds_write_b32 v152, v148 offset:556
    ds_write_b32 v152, v154 offset:4908
    v_cmpx_lt_u32 vcc, 12, v136
    s_cbranch_execz K2_CDONE
    v_mad_u32_u16 v153, v149, 32, v120
    ds_write_b32 v152, v149 offset:560
    ds_write_b32 v152, v153 offset:4912
    v_cmpx_lt_u32 vcc, 13, v136
    s_cbranch_execz K2_CDONE
    v_mad_u32_u16 v154, v150, 32, v120
    ds_write_b32 v152, v150 offset:564
    ds_write_b32 v152, v154 offset:4916
    v_cmpx_lt_u32 vcc, 14, v136
    s_cbranch_execz K2_CDONE
    v_mad_u32_u16 v153, v151, 32, v120
    ds_write_b32 v152, v151 offset:568
    ds_write_b32 v152, v153 offset:4920
K2_CDONE:
    s_mov_b64 exec, -1
K2_PROC:
    v_add_lshl_u32 v152, v7, s58, 2
    v_add_u32 v152, s48, v152
    v_mov_b32 v153, 0
    v_mov_b32 v154, 0x1e0
    ds_write_b32 v152, v153 offset:512
    ds_write_b32 v152, v154 offset:4864
    ds_write_b32 v152, v153 offset:768
    ds_write_b32 v152, v154 offset:5120
    s_add_u32 s63, s58, 31
    s_lshr_b32 s63, s63, 5
    s_max_u32 s59, s63, 2
    s_add_u32 s23, s58, 31
    s_and_b32 s23, s23, 16
    v_mov_b32 v2, v12
    v_mov_b32 v3, v13
    v_mov_b32 v4, v14
    v_mov_b32 v10, v15
    ds_read_b32 v8, v10 offset:0
    ds_read_b128 v[120:123], v2 offset:0
    ds_read_b128 v[124:127], v2 offset:64
    s_mov_b32 m0, s36
    s_waitcnt lgkmcnt(2)
    v_lshrrev_b32 v8, 9, v8
    buffer_load_dwordx4 v[8:9], s[32:35], 0 idxen offen  lds
    s_waitcnt lgkmcnt(0)
    v_perm_b32 v120, v120, v1, s50
    buffer_load_dwordx4 v[136:139], v120, s[28:31], 0 offen
    v_perm_b32 v121, v121, v1, s50
    buffer_load_dwordx4 v[140:143], v121, s[28:31], 0 offen
    v_perm_b32 v122, v122, v1, s50
    buffer_load_dwordx4 v[144:147], v122, s[28:31], 0 offen
    s_cmp_lg_u32 s49, 0
    s_cbranch_scc1 K2_I1
K2_P1:
    s_waitcnt vmcnt(4)
    ds_write_b128 v54, v[56:59] offset:0
    ds_write_b128 v54, v[60:63] offset:128
    ds_write_b128 v54, v[64:67] offset:18944
    ds_write_b128 v54, v[68:71] offset:19072
    s_cmp_ge_u32 s42, 2
    s_cbranch_scc1 K2_NOC
    ds_write_b128 v53, v[88:91]
K2_NOC:
    s_waitcnt lgkmcnt(0)
    s_barrier
K2_I1:
    v_perm_b32 v123, v123, v1, s50
    buffer_load_dwordx4 v[148:151], v123, s[28:31], 0 offen
    v_perm_b32 v124, v124, v1, s50
    buffer_load_dwordx4 v[152:155], v124, s[28:31], 0 offen
    v_perm_b32 v125, v125, v1, s50
    buffer_load_dwordx4 v[156:159], v125, s[28:31], 0 offen
    v_perm_b32 v126, v126, v1, s50
    buffer_load_dwordx4 v[160:163], v126, s[28:31], 0 offen
    v_perm_b32 v127, v127, v1, s50
    buffer_load_dwordx4 v[164:167], v127, s[28:31], 0 offen
    s_cmp_lg_u32 s49, 0
    s_cbranch_scc1 K2_I2
    s_mov_b32 s49, 1
    ds_read_b128 v[104:107], v236
    ds_read_b128 v[108:111], v237
    ds_read_b128 v[112:115], v238
    ds_read_b128 v[116:119], v239
    ds_read_b64_tr_b16 v[88:89], v55 offset:0
    ds_read_b64_tr_b16 v[90:91], v55 offset:32
    ds_read_b64_tr_b16 v[92:93], v55 offset:64
    ds_read_b64_tr_b16 v[94:95], v55 offset:96
    ds_read_b64_tr_b16 v[56:57], v52 offset:0
    ds_read_b64_tr_b16 v[58:59], v52 offset:1152
    ds_read_b64_tr_b16 v[60:61], v52 offset:32
    ds_read_b64_tr_b16 v[62:63], v52 offset:1184
    ds_read_b64_tr_b16 v[64:65], v52 offset:64
    ds_read_b64_tr_b16 v[66:67], v52 offset:1216
    ds_read_b64_tr_b16 v[68:69], v52 offset:96
    ds_read_b64_tr_b16 v[70:71], v52 offset:1248
    ds_read_b64_tr_b16 v[72:73], v52 offset:128
    ds_read_b64_tr_b16 v[74:75], v52 offset:1280
    ds_read_b64_tr_b16 v[76:77], v52 offset:160
    ds_read_b64_tr_b16 v[78:79], v52 offset:1312
    ds_read_b64_tr_b16 v[80:81], v52 offset:192
    ds_read_b64_tr_b16 v[82:83], v52 offset:1344
    ds_read_b64_tr_b16 v[84:85], v52 offset:224
    ds_read_b64_tr_b16 v[86:87], v52 offset:1376
    s_waitcnt lgkmcnt(8)
    v_mfma_f32_16x16x32_bf16 v[120:123], v[104:107], v[56:59], 0
    v_mfma_f32_16x16x32_bf16 v[124:127], v[104:107], v[60:63], 0
    v_mfma_f32_16x16x32_bf16 v[128:131], v[104:107], v[64:67], 0
    v_mfma_f32_16x16x32_bf16 v[132:135], v[104:107], v[68:71], 0
    ds_read_b64_tr_b16 v[56:57], v52 offset:9472
    ds_read_b64_tr_b16 v[58:59], v52 offset:10624
    ds_read_b64_tr_b16 v[60:61], v52 offset:9504
    ds_read_b64_tr_b16 v[62:63], v52 offset:10656
    ds_read_b64_tr_b16 v[64:65], v52 offset:9536
    ds_read_b64_tr_b16 v[66:67], v52 offset:10688
    ds_read_b64_tr_b16 v[68:69], v52 offset:9568
    ds_read_b64_tr_b16 v[70:71], v52 offset:10720
    s_waitcnt lgkmcnt(8)
    v_mfma_f32_16x16x32_bf16 v[32:35], v[104:107], v[72:75], 0
    v_mfma_f32_16x16x32_bf16 v[36:39], v[104:107], v[76:79], 0
    v_mfma_f32_16x16x32_bf16 v[40:43], v[104:107], v[80:83], 0
    v_mfma_f32_16x16x32_bf16 v[44:47], v[104:107], v[84:87], 0
    ds_read_b64_tr_b16 v[72:73], v52 offset:9600
    ds_read_b64_tr_b16 v[74:75], v52 offset:10752
    ds_read_b64_tr_b16 v[76:77], v52 offset:9632
    ds_read_b64_tr_b16 v[78:79], v52 offset:10784
    ds_read_b64_tr_b16 v[80:81], v52 offset:9664
    ds_read_b64_tr_b16 v[82:83], v52 offset:10816
    ds_read_b64_tr_b16 v[84:85], v52 offset:9696
    ds_read_b64_tr_b16 v[86:87], v52 offset:10848
    s_waitcnt lgkmcnt(8)
    v_mfma_f32_16x16x32_bf16 v[120:123], v[108:111], v[56:59], v[120:123]
    v_mfma_f32_16x16x32_bf16 v[124:127], v[108:111], v[60:63], v[124:127]
    v_mfma_f32_16x16x32_bf16 v[128:131], v[108:111], v[64:67], v[128:131]
    v_mfma_f32_16x16x32_bf16 v[132:135], v[108:111], v[68:71], v[132:135]
    ds_read_b64_tr_b16 v[56:57], v52 offset:18944
    ds_read_b64_tr_b16 v[58:59], v52 offset:20096
    ds_read_b64_tr_b16 v[60:61], v52 offset:18976
    ds_read_b64_tr_b16 v[62:63], v52 offset:20128
    ds_read_b64_tr_b16 v[64:65], v52 offset:19008
    ds_read_b64_tr_b16 v[66:67], v52 offset:20160
    ds_read_b64_tr_b16 v[68:69], v52 offset:19040
    ds_read_b64_tr_b16 v[70:71], v52 offset:20192
    s_waitcnt lgkmcnt(8)
    v_mfma_f32_16x16x32_bf16 v[32:35], v[108:111], v[72:75], v[32:35]
    v_mfma_f32_16x16x32_bf16 v[36:39], v[108:111], v[76:79], v[36:39]
    v_mfma_f32_16x16x32_bf16 v[40:43], v[108:111], v[80:83], v[40:43]
    v_mfma_f32_16x16x32_bf16 v[44:47], v[108:111], v[84:87], v[44:47]
    ds_read_b64_tr_b16 v[72:73], v52 offset:19072
    ds_read_b64_tr_b16 v[74:75], v52 offset:20224
    ds_read_b64_tr_b16 v[76:77], v52 offset:19104
    ds_read_b64_tr_b16 v[78:79], v52 offset:20256
    ds_read_b64_tr_b16 v[80:81], v52 offset:19136
    ds_read_b64_tr_b16 v[82:83], v52 offset:20288
    ds_read_b64_tr_b16 v[84:85], v52 offset:19168
    ds_read_b64_tr_b16 v[86:87], v52 offset:20320
    s_waitcnt lgkmcnt(8)
    v_mfma_f32_16x16x32_bf16 v[120:123], v[112:115], v[56:59], v[120:123]
    v_mfma_f32_16x16x32_bf16 v[124:127], v[112:115], v[60:63], v[124:127]
    v_mfma_f32_16x16x32_bf16 v[128:131], v[112:115], v[64:67], v[128:131]
    v_mfma_f32_16x16x32_bf16 v[132:135], v[112:115], v[68:71], v[132:135]
    ds_read_b64_tr_b16 v[56:57], v52 offset:28416
    ds_read_b64_tr_b16 v[58:59], v52 offset:29568
    ds_read_b64_tr_b16 v[60:61], v52 offset:28448
    ds_read_b64_tr_b16 v[62:63], v52 offset:29600
    ds_read_b64_tr_b16 v[64:65], v52 offset:28480
    ds_read_b64_tr_b16 v[66:67], v52 offset:29632
    ds_read_b64_tr_b16 v[68:69], v52 offset:28512
    ds_read_b64_tr_b16 v[70:71], v52 offset:29664
    s_waitcnt lgkmcnt(8)
    v_mfma_f32_16x16x32_bf16 v[32:35], v[112:115], v[72:75], v[32:35]
    v_mfma_f32_16x16x32_bf16 v[36:39], v[112:115], v[76:79], v[36:39]
    v_mfma_f32_16x16x32_bf16 v[40:43], v[112:115], v[80:83], v[40:43]
    v_mfma_f32_16x16x32_bf16 v[44:47], v[112:115], v[84:87], v[44:47]
    ds_read_b64_tr_b16 v[72:73], v52 offset:28544
    ds_read_b64_tr_b16 v[74:75], v52 offset:29696
    ds_read_b64_tr_b16 v[76:77], v52 offset:28576
    ds_read_b64_tr_b16 v[78:79], v52 offset:29728
    ds_read_b64_tr_b16 v[80:81], v52 offset:28608
    ds_read_b64_tr_b16 v[82:83], v52 offset:29760
    ds_read_b64_tr_b16 v[84:85], v52 offset:28640
    ds_read_b64_tr_b16 v[86:87], v52 offset:29792
    s_waitcnt lgkmcnt(8)
    v_mfma_f32_16x16x32_bf16 v[120:123], v[116:119], v[56:59], v[120:123]
    v_mfma_f32_16x16x32_bf16 v[124:127], v[116:119], v[60:63], v[124:127]
    v_mfma_f32_16x16x32_bf16 v[128:131], v[116:119], v[64:67], v[128:131]
    v_mfma_f32_16x16x32_bf16 v[132:135], v[116:119], v[68:71], v[132:135]
    s_waitcnt lgkmcnt(0)
    v_mfma_f32_16x16x32_bf16 v[32:35], v[116:119], v[72:75], v[32:35]
    v_mfma_f32_16x16x32_bf16 v[36:39], v[116:119], v[76:79], v[36:39]
    v_mfma_f32_16x16x32_bf16 v[40:43], v[116:119], v[80:83], v[40:43]
    v_mfma_f32_16x16x32_bf16 v[44:47], v[116:119], v[84:87], v[44:47]
    v_lshlrev_b32 v96, 16, v88
    v_and_b32 v97, 0xffff0000, v88
    v_pk_mul_f32 v[96:97], v[96:97], s[52:53]
    v_cvt_pk_bf16_f32 v16, v96, v97
    v_lshlrev_b32 v96, 16, v89
    v_and_b32 v97, 0xffff0000, v89
    v_pk_mul_f32 v[96:97], v[96:97], s[52:53]
    v_cvt_pk_bf16_f32 v17, v96, v97
    v_lshlrev_b32 v96, 16, v90
    v_and_b32 v97, 0xffff0000, v90
    v_pk_mul_f32 v[96:97], v[96:97], s[52:53]
    v_cvt_pk_bf16_f32 v20, v96, v97
    v_lshlrev_b32 v96, 16, v91
    v_and_b32 v97, 0xffff0000, v91
    v_pk_mul_f32 v[96:97], v[96:97], s[52:53]
    v_cvt_pk_bf16_f32 v21, v96, v97
    v_lshlrev_b32 v96, 16, v92
    v_and_b32 v97, 0xffff0000, v92
    v_pk_mul_f32 v[96:97], v[96:97], s[52:53]
    v_cvt_pk_bf16_f32 v24, v96, v97
    v_lshlrev_b32 v96, 16, v93
    v_and_b32 v97, 0xffff0000, v93
    v_pk_mul_f32 v[96:97], v[96:97], s[52:53]
    v_cvt_pk_bf16_f32 v25, v96, v97
    v_lshlrev_b32 v96, 16, v94
    v_and_b32 v97, 0xffff0000, v94
    v_pk_mul_f32 v[96:97], v[96:97], s[52:53]
    v_cvt_pk_bf16_f32 v28, v96, v97
    v_lshlrev_b32 v96, 16, v95
    v_and_b32 v97, 0xffff0000, v95
    v_pk_mul_f32 v[96:97], v[96:97], s[52:53]
    v_cvt_pk_bf16_f32 v29, v96, v97
    v_pk_mul_f32 v[120:121], v[120:121], s[52:53]
    v_cvt_pk_bf16_f32 v18, v120, v121
    v_pk_mul_f32 v[122:123], v[122:123], s[52:53]
    v_cvt_pk_bf16_f32 v19, v122, v123
    v_pk_mul_f32 v[124:125], v[124:125], s[52:53]
    v_cvt_pk_bf16_f32 v22, v124, v125
    v_pk_mul_f32 v[126:127], v[126:127], s[52:53]
    v_cvt_pk_bf16_f32 v23, v126, v127
    v_pk_mul_f32 v[128:129], v[128:129], s[52:53]
    v_cvt_pk_bf16_f32 v26, v128, v129
    v_pk_mul_f32 v[130:131], v[130:131], s[52:53]
    v_cvt_pk_bf16_f32 v27, v130, v131
    v_pk_mul_f32 v[132:133], v[132:133], s[52:53]
    v_cvt_pk_bf16_f32 v30, v132, v133
    v_pk_mul_f32 v[134:135], v[134:135], s[52:53]
    v_cvt_pk_bf16_f32 v31, v134, v135
    s_nop 1
K2_I2:
    ds_read_b32 v8, v10 offset:128
    ds_read_b128 v[120:123], v2 offset:128
    ds_read_b128 v[124:127], v2 offset:192
    s_mov_b32 m0, s37
    s_waitcnt lgkmcnt(2)
    v_lshrrev_b32 v8, 9, v8
    buffer_load_dwordx4 v[8:9], s[32:35], 0 idxen offen  lds
    s_waitcnt lgkmcnt(0)
    v_perm_b32 v120, v120, v1, s50
    buffer_load_dwordx4 v[168:171], v120, s[28:31], 0 offen
    v_perm_b32 v121, v121, v1, s50
    buffer_load_dwordx4 v[172:175], v121, s[28:31], 0 offen
    v_perm_b32 v122, v122, v1, s50
    buffer_load_dwordx4 v[176:179], v122, s[28:31], 0 offen
    v_perm_b32 v123, v123, v1, s50
    buffer_load_dwordx4 v[180:183], v123, s[28:31], 0 offen
    v_perm_b32 v124, v124, v1, s50
    buffer_load_dwordx4 v[184:187], v124, s[28:31], 0 offen
    v_perm_b32 v125, v125, v1, s50
    buffer_load_dwordx4 v[188:191], v125, s[28:31], 0 offen
    v_perm_b32 v126, v126, v1, s50
    buffer_load_dwordx4 v[192:195], v126, s[28:31], 0 offen
    v_perm_b32 v127, v127, v1, s50
    buffer_load_dwordx4 v[196:199], v127, s[28:31], 0 offen
    ds_read2_b32 v[52:53], v3 offset0:0 offset1:16
    s_waitcnt lgkmcnt(0)
    v_and_or_b32 v52, v52, s51, v5
    v_and_or_b32 v53, v53, s51, v5
    ds_read_b64 v[106:107], v52
    ds_read_b64 v[110:111], v53
    s_cmp_eq_u32 s63, 0
    s_cbranch_scc1 K2_NEXT
K2_LOOP:
    s_setprio 2
    s_cmp_ge_u32 s63, 3
    s_cbranch_scc1 K2_W10_0_0
    s_setprio 1
    s_cmp_ge_u32 s59, 2
    s_cbranch_scc1 K2_W10_0_0
    s_setprio 0
    s_waitcnt vmcnt(0)
    s_cmp_eq_u32 s23, 0
    s_cbranch_scc1 K2_H0
K2_W10_0_0:
    s_waitcnt vmcnt(9)
    ds_read_b64 v[104:105], v11 offset:9216
    ds_read_b64 v[108:109], v11 offset:9728
    ds_read2_b32 v[54:55], v4 offset0:0 offset1:16
    ds_read2_b32 v[52:53], v3 offset0:32 offset1:48
    ds_read_b128 v[120:123], v2 offset:256
    ds_read_b128 v[124:127], v2 offset:320
    ds_read_b32 v8, v10 offset:256
    s_mov_b32 m0, s38
    s_cmp_lt_u32 s63, 3
    v_lshlrev_b32 v56, 16, v136
    v_lshlrev_b32 v57, 16, v140
    v_lshlrev_b32 v58, 16, v144
    v_lshlrev_b32 v59, 16, v148
    v_lshlrev_b32 v60, 16, v137
    v_lshlrev_b32 v61, 16, v141
    v_lshlrev_b32 v62, 16, v145
    v_lshlrev_b32 v63, 16, v149
    v_lshlrev_b32 v64, 16, v138
    v_lshlrev_b32 v65, 16, v142
    v_lshlrev_b32 v66, 16, v146
    v_lshlrev_b32 v67, 16, v150
    v_lshlrev_b32 v68, 16, v139
    v_lshlrev_b32 v69, 16, v143
    v_lshlrev_b32 v70, 16, v147
    v_lshlrev_b32 v71, 16, v151
    v_lshlrev_b32 v72, 16, v152
    v_lshlrev_b32 v73, 16, v156
    v_lshlrev_b32 v74, 16, v160
    v_lshlrev_b32 v75, 16, v164
    s_waitcnt lgkmcnt(5)
    v_mfma_f32_16x16x32_bf16 v[56:59], v[104:107], v[16:19], v[56:59]
    v_lshlrev_b32 v76, 16, v153
    v_lshlrev_b32 v77, 16, v157
    v_lshlrev_b32 v78, 16, v161
    v_lshlrev_b32 v79, 16, v165
    v_mfma_f32_16x16x32_bf16 v[60:63], v[104:107], v[20:23], v[60:63]
    v_lshlrev_b32 v80, 16, v154
    v_lshlrev_b32 v81, 16, v158
    v_lshlrev_b32 v82, 16, v162
    v_lshlrev_b32 v83, 16, v166
    v_mfma_f32_16x16x32_bf16 v[64:67], v[104:107], v[24:27], v[64:67]
    v_lshlrev_b32 v84, 16, v155
    v_lshlrev_b32 v85, 16, v159
    v_lshlrev_b32 v86, 16, v163
    v_lshlrev_b32 v87, 16, v167
    v_mfma_f32_16x16x32_bf16 v[68:71], v[104:107], v[28:31], v[68:71]
    s_waitcnt lgkmcnt(3)
    v_and_or_b32 v54, v54, s51, v6
    v_and_or_b32 v55, v55, s51, v6
    v_and_or_b32 v52, v52, s51, v5
    v_and_or_b32 v53, v53, s51, v5
    v_mfma_f32_16x16x32_bf16 v[72:75], v[108:111], v[16:19], v[72:75]
    v_exp_f32 v88, v56
    v_exp_f32 v92, v57
    v_exp_f32 v96, v58
    v_exp_f32 v100, v59
    v_mfma_f32_16x16x32_bf16 v[76:79], v[108:111], v[20:23], v[76:79]
    v_exp_f32 v89, v60
    v_exp_f32 v93, v61
    v_exp_f32 v97, v62
    v_exp_f32 v101, v63
    v_mfma_f32_16x16x32_bf16 v[80:83], v[108:111], v[24:27], v[80:83]
    v_exp_f32 v90, v64
    v_exp_f32 v94, v65
    v_exp_f32 v98, v66
    v_exp_f32 v102, v67
    v_mfma_f32_16x16x32_bf16 v[84:87], v[108:111], v[28:31], v[84:87]
    v_exp_f32 v91, v68
    v_exp_f32 v95, v69
    v_exp_f32 v99, v70
    v_exp_f32 v103, v71
    ds_read_b64_tr_b16 v[48:49], v54
    ds_read_b64_tr_b16 v[50:51], v55
    ds_read_b64 v[106:107], v52
    ds_read_b64 v[110:111], v53
    s_waitcnt lgkmcnt(4)
    v_pk_add_f32 v[88:89], v[88:89], s[54:55]
    v_pk_add_f32 v[90:91], v[90:91], s[54:55]
    v_pk_add_f32 v[92:93], v[92:93], s[54:55]
    v_pk_add_f32 v[94:95], v[94:95], s[54:55]
    v_pk_add_f32 v[96:97], v[96:97], s[54:55]
    v_pk_add_f32 v[98:99], v[98:99], s[54:55]
    v_pk_add_f32 v[100:101], v[100:101], s[54:55]
    v_pk_add_f32 v[102:103], v[102:103], s[54:55]
    v_rcp_f32 v88, v88
    v_rcp_f32 v89, v89
    v_rcp_f32 v90, v90
    v_rcp_f32 v91, v91
    s_cbranch_scc1 K2_S0_0_0
    v_perm_b32 v120, v120, v1, s50
    buffer_load_dwordx4 v[200:203], v120, s[28:31], 0 offen
K2_S0_0_0:
    v_rcp_f32 v92, v92
    v_rcp_f32 v93, v93
    v_rcp_f32 v94, v94
    v_rcp_f32 v95, v95
    s_cbranch_scc1 K2_S0_0_1
    v_perm_b32 v121, v121, v1, s50
    buffer_load_dwordx4 v[204:207], v121, s[28:31], 0 offen
K2_S0_0_1:
    v_rcp_f32 v96, v96
    v_rcp_f32 v97, v97
    v_rcp_f32 v98, v98
    v_rcp_f32 v99, v99
    s_cbranch_scc1 K2_S0_0_2
    v_perm_b32 v122, v122, v1, s50
    buffer_load_dwordx4 v[208:211], v122, s[28:31], 0 offen
K2_S0_0_2:
    v_rcp_f32 v100, v100
    v_rcp_f32 v101, v101
    v_rcp_f32 v102, v102
    v_rcp_f32 v103, v103
    s_cbranch_scc1 K2_S0_0_3
    v_perm_b32 v123, v123, v1, s50
    buffer_load_dwordx4 v[212:215], v123, s[28:31], 0 offen
K2_S0_0_3:
    v_pk_mul_f32 v[88:89], v[88:89], v[136:137]
    v_pk_mul_f32 v[90:91], v[90:91], v[138:139]
    v_pk_mul_f32 v[92:93], v[92:93], v[140:141]
    v_pk_mul_f32 v[94:95], v[94:95], v[142:143]
    v_pk_mul_f32 v[96:97], v[96:97], v[144:145]
    v_pk_mul_f32 v[98:99], v[98:99], v[146:147]
    v_pk_mul_f32 v[100:101], v[100:101], v[148:149]
    v_pk_mul_f32 v[102:103], v[102:103], v[150:151]
    v_cvt_pk_bf16_f32 v56, v88, v92
    v_cvt_pk_bf16_f32 v57, v96, v100
    v_cvt_pk_bf16_f32 v60, v89, v93
    v_cvt_pk_bf16_f32 v61, v97, v101
    v_cvt_pk_bf16_f32 v64, v90, v94
    v_cvt_pk_bf16_f32 v65, v98, v102
    v_cvt_pk_bf16_f32 v68, v91, v95
    v_cvt_pk_bf16_f32 v69, v99, v103
    v_exp_f32 v88, v72
    v_exp_f32 v92, v73
    v_exp_f32 v96, v74
    v_exp_f32 v100, v75
    v_exp_f32 v89, v76
    v_exp_f32 v93, v77
    v_exp_f32 v97, v78
    v_exp_f32 v101, v79
    s_cbranch_scc1 K2_S0_0_4
    v_perm_b32 v124, v124, v1, s50
    buffer_load_dwordx4 v[216:219], v124, s[28:31], 0 offen
K2_S0_0_4:
    v_exp_f32 v90, v80
    v_exp_f32 v94, v81
    v_exp_f32 v98, v82
    v_exp_f32 v102, v83
    v_exp_f32 v91, v84
    v_exp_f32 v95, v85
    v_exp_f32 v99, v86
    v_exp_f32 v103, v87
    s_cbranch_scc1 K2_S0_0_5
    v_perm_b32 v125, v125, v1, s50
    buffer_load_dwordx4 v[220:223], v125, s[28:31], 0 offen
K2_S0_0_5:
    v_pk_add_f32 v[88:89], v[88:89], s[54:55]
    v_pk_add_f32 v[90:91], v[90:91], s[54:55]
    v_pk_add_f32 v[92:93], v[92:93], s[54:55]
    v_pk_add_f32 v[94:95], v[94:95], s[54:55]
    v_pk_add_f32 v[96:97], v[96:97], s[54:55]
    v_pk_add_f32 v[98:99], v[98:99], s[54:55]
    v_pk_add_f32 v[100:101], v[100:101], s[54:55]
    v_pk_add_f32 v[102:103], v[102:103], s[54:55]
    v_rcp_f32 v88, v88
    v_rcp_f32 v89, v89
    v_rcp_f32 v90, v90
    v_rcp_f32 v91, v91
    s_cbranch_scc1 K2_S0_0_6
    v_perm_b32 v126, v126, v1, s50
    buffer_load_dwordx4 v[224:227], v126, s[28:31], 0 offen
K2_S0_0_6:
    v_rcp_f32 v92, v92
    v_rcp_f32 v93, v93
    v_rcp_f32 v94, v94
    v_rcp_f32 v95, v95
    v_rcp_f32 v96, v96
    v_rcp_f32 v97, v97
    s_cbranch_scc1 K2_S0_0_7
    v_perm_b32 v127, v127, v1, s50
    buffer_load_dwordx4 v[228:231], v127, s[28:31], 0 offen
K2_S0_0_7:
    v_rcp_f32 v98, v98
    v_rcp_f32 v99, v99
    v_rcp_f32 v100, v100
    v_rcp_f32 v101, v101
    v_rcp_f32 v102, v102
    v_rcp_f32 v103, v103
    s_cbranch_scc1 K2_S0_0_8
    v_lshrrev_b32 v8, 9, v8
    buffer_load_dwordx4 v[8:9], s[32:35], 0 idxen offen  lds
K2_S0_0_8:
    v_pk_mul_f32 v[88:89], v[88:89], v[152:153]
    v_pk_mul_f32 v[90:91], v[90:91], v[154:155]
    v_pk_mul_f32 v[92:93], v[92:93], v[156:157]
    v_pk_mul_f32 v[94:95], v[94:95], v[158:159]
    v_pk_mul_f32 v[96:97], v[96:97], v[160:161]
    v_pk_mul_f32 v[98:99], v[98:99], v[162:163]
    v_pk_mul_f32 v[100:101], v[100:101], v[164:165]
    v_pk_mul_f32 v[102:103], v[102:103], v[166:167]
    s_waitcnt lgkmcnt(2)
    v_cvt_pk_bf16_f32 v58, v88, v92
    v_cvt_pk_bf16_f32 v59, v96, v100
    v_cvt_pk_bf16_f32 v62, v89, v93
    v_cvt_pk_bf16_f32 v63, v97, v101
    v_mfma_f32_16x16x32_bf16 v[32:35], v[48:51], v[56:59], v[32:35]
    v_cvt_pk_bf16_f32 v66, v90, v94
    v_cvt_pk_bf16_f32 v67, v98, v102
    v_mfma_f32_16x16x32_bf16 v[36:39], v[48:51], v[60:63], v[36:39]
    v_cvt_pk_bf16_f32 v70, v91, v95
    v_cvt_pk_bf16_f32 v71, v99, v103
    v_mfma_f32_16x16x32_bf16 v[40:43], v[48:51], v[64:67], v[40:43]
    s_sub_u32 s59, s59, 1
    s_sub_u32 s63, s63, 1
    v_mfma_f32_16x16x32_bf16 v[44:47], v[48:51], v[68:71], v[44:47]
    s_cmp_eq_u32 s63, 0
    s_cbranch_scc1 K2_NEXT
K2_B1:
    s_setprio 2
    s_cmp_ge_u32 s63, 3
    s_cbranch_scc1 K2_W10_1_0
    s_setprio 1
    s_cmp_ge_u32 s59, 2
    s_cbranch_scc1 K2_W10_1_0
    s_setprio 0
    s_waitcnt vmcnt(0)
    s_cmp_eq_u32 s23, 0
    s_cbranch_scc1 K2_H1
K2_W10_1_0:
    s_waitcnt vmcnt(9)
    ds_read_b64 v[104:105], v11 offset:10240
    ds_read_b64 v[108:109], v11 offset:10752
    v_add_u32 v2, 384, v2
    v_add_u32 v10, 384, v10
    ds_read2_b32 v[54:55], v4 offset0:32 offset1:48
    ds_read2_b32 v[52:53], v3 offset0:64 offset1:80
    ds_read_b128 v[120:123], v2 offset:0
    ds_read_b128 v[124:127], v2 offset:64
    ds_read_b32 v8, v10 offset:0
    s_mov_b32 m0, s36
    s_cmp_lt_u32 s63, 3
    v_lshlrev_b32 v56, 16, v168
    v_lshlrev_b32 v57, 16, v172
    v_lshlrev_b32 v58, 16, v176
    v_lshlrev_b32 v59, 16, v180
    v_lshlrev_b32 v60, 16, v169
    v_lshlrev_b32 v61, 16, v173
    v_lshlrev_b32 v62, 16, v177
    v_lshlrev_b32 v63, 16, v181
    v_lshlrev_b32 v64, 16, v170
    v_lshlrev_b32 v65, 16, v174
    v_lshlrev_b32 v66, 16, v178
    v_lshlrev_b32 v67, 16, v182
    v_lshlrev_b32 v68, 16, v171
    v_lshlrev_b32 v69, 16, v175
    v_lshlrev_b32 v70, 16, v179
    v_lshlrev_b32 v71, 16, v183
    v_lshlrev_b32 v72, 16, v184
    v_lshlrev_b32 v73, 16, v188
    v_lshlrev_b32 v74, 16, v192
    v_lshlrev_b32 v75, 16, v196
    s_waitcnt lgkmcnt(5)
    v_mfma_f32_16x16x32_bf16 v[56:59], v[104:107], v[16:19], v[56:59]
    v_lshlrev_b32 v76, 16, v185
    v_lshlrev_b32 v77, 16, v189
    v_lshlrev_b32 v78, 16, v193
    v_lshlrev_b32 v79, 16, v197
    v_mfma_f32_16x16x32_bf16 v[60:63], v[104:107], v[20:23], v[60:63]
    v_lshlrev_b32 v80, 16, v186
    v_lshlrev_b32 v81, 16, v190
    v_lshlrev_b32 v82, 16, v194
    v_lshlrev_b32 v83, 16, v198
    v_mfma_f32_16x16x32_bf16 v[64:67], v[104:107], v[24:27], v[64:67]
    v_lshlrev_b32 v84, 16, v187
    v_lshlrev_b32 v85, 16, v191
    v_lshlrev_b32 v86, 16, v195
    v_lshlrev_b32 v87, 16, v199
    v_mfma_f32_16x16x32_bf16 v[68:71], v[104:107], v[28:31], v[68:71]
    s_waitcnt lgkmcnt(3)
    v_and_or_b32 v54, v54, s51, v6
    v_and_or_b32 v55, v55, s51, v6
    v_and_or_b32 v52, v52, s51, v5
    v_and_or_b32 v53, v53, s51, v5
    v_mfma_f32_16x16x32_bf16 v[72:75], v[108:111], v[16:19], v[72:75]
    v_exp_f32 v88, v56
    v_exp_f32 v92, v57
    v_exp_f32 v96, v58
    v_exp_f32 v100, v59
    v_mfma_f32_16x16x32_bf16 v[76:79], v[108:111], v[20:23], v[76:79]
    v_exp_f32 v89, v60
    v_exp_f32 v93, v61
    v_exp_f32 v97, v62
    v_exp_f32 v101, v63
    v_mfma_f32_16x16x32_bf16 v[80:83], v[108:111], v[24:27], v[80:83]
    v_exp_f32 v90, v64
    v_exp_f32 v94, v65
    v_exp_f32 v98, v66
    v_exp_f32 v102, v67
    v_mfma_f32_16x16x32_bf16 v[84:87], v[108:111], v[28:31], v[84:87]
    v_exp_f32 v91, v68
    v_exp_f32 v95, v69
    v_exp_f32 v99, v70
    v_exp_f32 v103, v71
    ds_read_b64_tr_b16 v[48:49], v54
    ds_read_b64_tr_b16 v[50:51], v55
    ds_read_b64 v[106:107], v52
    ds_read_b64 v[110:111], v53
    s_waitcnt lgkmcnt(4)
    v_pk_add_f32 v[88:89], v[88:89], s[54:55]
    v_pk_add_f32 v[90:91], v[90:91], s[54:55]
    v_pk_add_f32 v[92:93], v[92:93], s[54:55]
    v_pk_add_f32 v[94:95], v[94:95], s[54:55]
    v_pk_add_f32 v[96:97], v[96:97], s[54:55]
    v_pk_add_f32 v[98:99], v[98:99], s[54:55]
    v_pk_add_f32 v[100:101], v[100:101], s[54:55]
    v_pk_add_f32 v[102:103], v[102:103], s[54:55]
    v_rcp_f32 v88, v88
    v_rcp_f32 v89, v89
    v_rcp_f32 v90, v90
    v_rcp_f32 v91, v91
    s_cbranch_scc1 K2_S1_0_0
    v_perm_b32 v120, v120, v1, s50
    buffer_load_dwordx4 v[136:139], v120, s[28:31], 0 offen
K2_S1_0_0:
    v_rcp_f32 v92, v92
    v_rcp_f32 v93, v93
    v_rcp_f32 v94, v94
    v_rcp_f32 v95, v95
    s_cbranch_scc1 K2_S1_0_1
    v_perm_b32 v121, v121, v1, s50
    buffer_load_dwordx4 v[140:143], v121, s[28:31], 0 offen
K2_S1_0_1:
    v_rcp_f32 v96, v96
    v_rcp_f32 v97, v97
    v_rcp_f32 v98, v98
    v_rcp_f32 v99, v99
    s_cbranch_scc1 K2_S1_0_2
    v_perm_b32 v122, v122, v1, s50
    buffer_load_dwordx4 v[144:147], v122, s[28:31], 0 offen
K2_S1_0_2:
    v_rcp_f32 v100, v100
    v_rcp_f32 v101, v101
    v_rcp_f32 v102, v102
    v_rcp_f32 v103, v103
    s_cbranch_scc1 K2_S1_0_3
    v_perm_b32 v123, v123, v1, s50
    buffer_load_dwordx4 v[148:151], v123, s[28:31], 0 offen
K2_S1_0_3:
    v_pk_mul_f32 v[88:89], v[88:89], v[168:169]
    v_pk_mul_f32 v[90:91], v[90:91], v[170:171]
    v_pk_mul_f32 v[92:93], v[92:93], v[172:173]
    v_pk_mul_f32 v[94:95], v[94:95], v[174:175]
    v_pk_mul_f32 v[96:97], v[96:97], v[176:177]
    v_pk_mul_f32 v[98:99], v[98:99], v[178:179]
    v_pk_mul_f32 v[100:101], v[100:101], v[180:181]
    v_pk_mul_f32 v[102:103], v[102:103], v[182:183]
    v_cvt_pk_bf16_f32 v56, v88, v92
    v_cvt_pk_bf16_f32 v57, v96, v100
    v_cvt_pk_bf16_f32 v60, v89, v93
    v_cvt_pk_bf16_f32 v61, v97, v101
    v_cvt_pk_bf16_f32 v64, v90, v94
    v_cvt_pk_bf16_f32 v65, v98, v102
    v_cvt_pk_bf16_f32 v68, v91, v95
    v_cvt_pk_bf16_f32 v69, v99, v103
    v_exp_f32 v88, v72
    v_exp_f32 v92, v73
    v_exp_f32 v96, v74
    v_exp_f32 v100, v75
    v_exp_f32 v89, v76
    v_exp_f32 v93, v77
    v_exp_f32 v97, v78
    v_exp_f32 v101, v79
    s_cbranch_scc1 K2_S1_0_4
    v_perm_b32 v124, v124, v1, s50
    buffer_load_dwordx4 v[152:155], v124, s[28:31], 0 offen
K2_S1_0_4:
    v_exp_f32 v90, v80
    v_exp_f32 v94, v81
    v_exp_f32 v98, v82
    v_exp_f32 v102, v83
    v_exp_f32 v91, v84
    v_exp_f32 v95, v85
    v_exp_f32 v99, v86
    v_exp_f32 v103, v87
    s_cbranch_scc1 K2_S1_0_5
    v_perm_b32 v125, v125, v1, s50
    buffer_load_dwordx4 v[156:159], v125, s[28:31], 0 offen
K2_S1_0_5:
    v_pk_add_f32 v[88:89], v[88:89], s[54:55]
    v_pk_add_f32 v[90:91], v[90:91], s[54:55]
    v_pk_add_f32 v[92:93], v[92:93], s[54:55]
    v_pk_add_f32 v[94:95], v[94:95], s[54:55]
    v_pk_add_f32 v[96:97], v[96:97], s[54:55]
    v_pk_add_f32 v[98:99], v[98:99], s[54:55]
    v_pk_add_f32 v[100:101], v[100:101], s[54:55]
    v_pk_add_f32 v[102:103], v[102:103], s[54:55]
    v_rcp_f32 v88, v88
    v_rcp_f32 v89, v89
    v_rcp_f32 v90, v90
    v_rcp_f32 v91, v91
    s_cbranch_scc1 K2_S1_0_6
    v_perm_b32 v126, v126, v1, s50
    buffer_load_dwordx4 v[160:163], v126, s[28:31], 0 offen
K2_S1_0_6:
    v_rcp_f32 v92, v92
    v_rcp_f32 v93, v93
    v_rcp_f32 v94, v94
    v_rcp_f32 v95, v95
    v_rcp_f32 v96, v96
    v_rcp_f32 v97, v97
    s_cbranch_scc1 K2_S1_0_7
    v_perm_b32 v127, v127, v1, s50
    buffer_load_dwordx4 v[164:167], v127, s[28:31], 0 offen
K2_S1_0_7:
    v_rcp_f32 v98, v98
    v_rcp_f32 v99, v99
    v_rcp_f32 v100, v100
    v_rcp_f32 v101, v101
    v_rcp_f32 v102, v102
    v_rcp_f32 v103, v103
    s_cbranch_scc1 K2_S1_0_8
    v_lshrrev_b32 v8, 9, v8
    buffer_load_dwordx4 v[8:9], s[32:35], 0 idxen offen  lds
K2_S1_0_8:
    v_pk_mul_f32 v[88:89], v[88:89], v[184:185]
    v_pk_mul_f32 v[90:91], v[90:91], v[186:187]
    v_pk_mul_f32 v[92:93], v[92:93], v[188:189]
    v_pk_mul_f32 v[94:95], v[94:95], v[190:191]
    v_pk_mul_f32 v[96:97], v[96:97], v[192:193]
    v_pk_mul_f32 v[98:99], v[98:99], v[194:195]
    v_pk_mul_f32 v[100:101], v[100:101], v[196:197]
    v_pk_mul_f32 v[102:103], v[102:103], v[198:199]
    s_waitcnt lgkmcnt(2)
    v_cvt_pk_bf16_f32 v58, v88, v92
    v_cvt_pk_bf16_f32 v59, v96, v100
    v_cvt_pk_bf16_f32 v62, v89, v93
    v_cvt_pk_bf16_f32 v63, v97, v101
    v_mfma_f32_16x16x32_bf16 v[32:35], v[48:51], v[56:59], v[32:35]
    v_cvt_pk_bf16_f32 v66, v90, v94
    v_cvt_pk_bf16_f32 v67, v98, v102
    v_mfma_f32_16x16x32_bf16 v[36:39], v[48:51], v[60:63], v[36:39]
    v_cvt_pk_bf16_f32 v70, v91, v95
    v_cvt_pk_bf16_f32 v71, v99, v103
    v_mfma_f32_16x16x32_bf16 v[40:43], v[48:51], v[64:67], v[40:43]
    s_sub_u32 s59, s59, 1
    s_sub_u32 s63, s63, 1
    v_mfma_f32_16x16x32_bf16 v[44:47], v[48:51], v[68:71], v[44:47]
    s_cmp_eq_u32 s63, 0
    s_cbranch_scc1 K2_NEXT
    s_setprio 2
    s_cmp_ge_u32 s63, 3
    s_cbranch_scc1 K2_W10_2_0
    s_setprio 1
    s_cmp_ge_u32 s59, 2
    s_cbranch_scc1 K2_W10_2_0
    s_setprio 0
    s_waitcnt vmcnt(0)
    s_cmp_eq_u32 s23, 0
    s_cbranch_scc1 K2_H2
K2_W10_2_0:
    s_waitcnt vmcnt(9)
    ds_read_b64 v[104:105], v11 offset:11264
    ds_read_b64 v[108:109], v11 offset:11776
    ds_read2_b32 v[54:55], v4 offset0:64 offset1:80
    ds_read2_b32 v[52:53], v3 offset0:96 offset1:112
    ds_read_b128 v[120:123], v2 offset:128
    ds_read_b128 v[124:127], v2 offset:192
    ds_read_b32 v8, v10 offset:128
    s_mov_b32 m0, s37
    s_cmp_lt_u32 s63, 3
    v_lshlrev_b32 v56, 16, v200
    v_lshlrev_b32 v57, 16, v204
    v_lshlrev_b32 v58, 16, v208
    v_lshlrev_b32 v59, 16, v212
    v_lshlrev_b32 v60, 16, v201
    v_lshlrev_b32 v61, 16, v205
    v_lshlrev_b32 v62, 16, v209
    v_lshlrev_b32 v63, 16, v213
    v_lshlrev_b32 v64, 16, v202
    v_lshlrev_b32 v65, 16, v206
    v_lshlrev_b32 v66, 16, v210
    v_lshlrev_b32 v67, 16, v214
    v_lshlrev_b32 v68, 16, v203
    v_lshlrev_b32 v69, 16, v207
    v_lshlrev_b32 v70, 16, v211
    v_lshlrev_b32 v71, 16, v215
    v_lshlrev_b32 v72, 16, v216
    v_lshlrev_b32 v73, 16, v220
    v_lshlrev_b32 v74, 16, v224
    v_lshlrev_b32 v75, 16, v228
    s_waitcnt lgkmcnt(5)
    v_mfma_f32_16x16x32_bf16 v[56:59], v[104:107], v[16:19], v[56:59]
    v_lshlrev_b32 v76, 16, v217
    v_lshlrev_b32 v77, 16, v221
    v_lshlrev_b32 v78, 16, v225
    v_lshlrev_b32 v79, 16, v229
    v_mfma_f32_16x16x32_bf16 v[60:63], v[104:107], v[20:23], v[60:63]
    v_lshlrev_b32 v80, 16, v218
    v_lshlrev_b32 v81, 16, v222
    v_lshlrev_b32 v82, 16, v226
    v_lshlrev_b32 v83, 16, v230
    v_mfma_f32_16x16x32_bf16 v[64:67], v[104:107], v[24:27], v[64:67]
    v_lshlrev_b32 v84, 16, v219
    v_lshlrev_b32 v85, 16, v223
    v_lshlrev_b32 v86, 16, v227
    v_lshlrev_b32 v87, 16, v231
    v_mfma_f32_16x16x32_bf16 v[68:71], v[104:107], v[28:31], v[68:71]
    s_waitcnt lgkmcnt(3)
    v_and_or_b32 v54, v54, s51, v6
    v_and_or_b32 v55, v55, s51, v6
    v_and_or_b32 v52, v52, s51, v5
    v_and_or_b32 v53, v53, s51, v5
    v_mfma_f32_16x16x32_bf16 v[72:75], v[108:111], v[16:19], v[72:75]
    v_exp_f32 v88, v56
    v_exp_f32 v92, v57
    v_exp_f32 v96, v58
    v_exp_f32 v100, v59
    v_mfma_f32_16x16x32_bf16 v[76:79], v[108:111], v[20:23], v[76:79]
    v_exp_f32 v89, v60
    v_exp_f32 v93, v61
    v_exp_f32 v97, v62
    v_exp_f32 v101, v63
    v_mfma_f32_16x16x32_bf16 v[80:83], v[108:111], v[24:27], v[80:83]
    v_exp_f32 v90, v64
    v_exp_f32 v94, v65
    v_exp_f32 v98, v66
    v_exp_f32 v102, v67
    v_mfma_f32_16x16x32_bf16 v[84:87], v[108:111], v[28:31], v[84:87]
    v_exp_f32 v91, v68
    v_exp_f32 v95, v69
    v_exp_f32 v99, v70
    v_exp_f32 v103, v71
    ds_read_b64_tr_b16 v[48:49], v54
    ds_read_b64_tr_b16 v[50:51], v55
    ds_read_b64 v[106:107], v52
    ds_read_b64 v[110:111], v53
    s_waitcnt lgkmcnt(4)
    v_pk_add_f32 v[88:89], v[88:89], s[54:55]
    v_pk_add_f32 v[90:91], v[90:91], s[54:55]
    v_pk_add_f32 v[92:93], v[92:93], s[54:55]
    v_pk_add_f32 v[94:95], v[94:95], s[54:55]
    v_pk_add_f32 v[96:97], v[96:97], s[54:55]
    v_pk_add_f32 v[98:99], v[98:99], s[54:55]
    v_pk_add_f32 v[100:101], v[100:101], s[54:55]
    v_pk_add_f32 v[102:103], v[102:103], s[54:55]
    v_rcp_f32 v88, v88
    v_rcp_f32 v89, v89
    v_rcp_f32 v90, v90
    v_rcp_f32 v91, v91
    s_cbranch_scc1 K2_S2_0_0
    v_perm_b32 v120, v120, v1, s50
    buffer_load_dwordx4 v[168:171], v120, s[28:31], 0 offen
K2_S2_0_0:
    v_rcp_f32 v92, v92
    v_rcp_f32 v93, v93
    v_rcp_f32 v94, v94
    v_rcp_f32 v95, v95
    s_cbranch_scc1 K2_S2_0_1
    v_perm_b32 v121, v121, v1, s50
    buffer_load_dwordx4 v[172:175], v121, s[28:31], 0 offen
K2_S2_0_1:
    v_rcp_f32 v96, v96
    v_rcp_f32 v97, v97
    v_rcp_f32 v98, v98
    v_rcp_f32 v99, v99
    s_cbranch_scc1 K2_S2_0_2
    v_perm_b32 v122, v122, v1, s50
    buffer_load_dwordx4 v[176:179], v122, s[28:31], 0 offen
K2_S2_0_2:
    v_rcp_f32 v100, v100
    v_rcp_f32 v101, v101
    v_rcp_f32 v102, v102
    v_rcp_f32 v103, v103
    s_cbranch_scc1 K2_S2_0_3
    v_perm_b32 v123, v123, v1, s50
    buffer_load_dwordx4 v[180:183], v123, s[28:31], 0 offen
K2_S2_0_3:
    v_pk_mul_f32 v[88:89], v[88:89], v[200:201]
    v_pk_mul_f32 v[90:91], v[90:91], v[202:203]
    v_pk_mul_f32 v[92:93], v[92:93], v[204:205]
    v_pk_mul_f32 v[94:95], v[94:95], v[206:207]
    v_pk_mul_f32 v[96:97], v[96:97], v[208:209]
    v_pk_mul_f32 v[98:99], v[98:99], v[210:211]
    v_pk_mul_f32 v[100:101], v[100:101], v[212:213]
    v_pk_mul_f32 v[102:103], v[102:103], v[214:215]
    v_cvt_pk_bf16_f32 v56, v88, v92
    v_cvt_pk_bf16_f32 v57, v96, v100
    v_cvt_pk_bf16_f32 v60, v89, v93
    v_cvt_pk_bf16_f32 v61, v97, v101
    v_cvt_pk_bf16_f32 v64, v90, v94
    v_cvt_pk_bf16_f32 v65, v98, v102
    v_cvt_pk_bf16_f32 v68, v91, v95
    v_cvt_pk_bf16_f32 v69, v99, v103
    v_exp_f32 v88, v72
    v_exp_f32 v92, v73
    v_exp_f32 v96, v74
    v_exp_f32 v100, v75
    v_exp_f32 v89, v76
    v_exp_f32 v93, v77
    v_exp_f32 v97, v78
    v_exp_f32 v101, v79
    s_cbranch_scc1 K2_S2_0_4
    v_perm_b32 v124, v124, v1, s50
    buffer_load_dwordx4 v[184:187], v124, s[28:31], 0 offen
K2_S2_0_4:
    v_exp_f32 v90, v80
    v_exp_f32 v94, v81
    v_exp_f32 v98, v82
    v_exp_f32 v102, v83
    v_exp_f32 v91, v84
    v_exp_f32 v95, v85
    v_exp_f32 v99, v86
    v_exp_f32 v103, v87
    s_cbranch_scc1 K2_S2_0_5
    v_perm_b32 v125, v125, v1, s50
    buffer_load_dwordx4 v[188:191], v125, s[28:31], 0 offen
K2_S2_0_5:
    v_pk_add_f32 v[88:89], v[88:89], s[54:55]
    v_pk_add_f32 v[90:91], v[90:91], s[54:55]
    v_pk_add_f32 v[92:93], v[92:93], s[54:55]
    v_pk_add_f32 v[94:95], v[94:95], s[54:55]
    v_pk_add_f32 v[96:97], v[96:97], s[54:55]
    v_pk_add_f32 v[98:99], v[98:99], s[54:55]
    v_pk_add_f32 v[100:101], v[100:101], s[54:55]
    v_pk_add_f32 v[102:103], v[102:103], s[54:55]
    v_rcp_f32 v88, v88
    v_rcp_f32 v89, v89
    v_rcp_f32 v90, v90
    v_rcp_f32 v91, v91
    s_cbranch_scc1 K2_S2_0_6
    v_perm_b32 v126, v126, v1, s50
    buffer_load_dwordx4 v[192:195], v126, s[28:31], 0 offen
K2_S2_0_6:
    v_rcp_f32 v92, v92
    v_rcp_f32 v93, v93
    v_rcp_f32 v94, v94
    v_rcp_f32 v95, v95
    v_rcp_f32 v96, v96
    v_rcp_f32 v97, v97
    s_cbranch_scc1 K2_S2_0_7
    v_perm_b32 v127, v127, v1, s50
    buffer_load_dwordx4 v[196:199], v127, s[28:31], 0 offen
K2_S2_0_7:
    v_rcp_f32 v98, v98
    v_rcp_f32 v99, v99
    v_rcp_f32 v100, v100
    v_rcp_f32 v101, v101
    v_rcp_f32 v102, v102
    v_rcp_f32 v103, v103
    s_cbranch_scc1 K2_S2_0_8
    v_lshrrev_b32 v8, 9, v8
    buffer_load_dwordx4 v[8:9], s[32:35], 0 idxen offen  lds
K2_S2_0_8:
    v_pk_mul_f32 v[88:89], v[88:89], v[216:217]
    v_pk_mul_f32 v[90:91], v[90:91], v[218:219]
    v_pk_mul_f32 v[92:93], v[92:93], v[220:221]
    v_pk_mul_f32 v[94:95], v[94:95], v[222:223]
    v_pk_mul_f32 v[96:97], v[96:97], v[224:225]
    v_pk_mul_f32 v[98:99], v[98:99], v[226:227]
    v_pk_mul_f32 v[100:101], v[100:101], v[228:229]
    v_pk_mul_f32 v[102:103], v[102:103], v[230:231]
    s_waitcnt lgkmcnt(2)
    v_cvt_pk_bf16_f32 v58, v88, v92
    v_cvt_pk_bf16_f32 v59, v96, v100
    v_cvt_pk_bf16_f32 v62, v89, v93
    v_cvt_pk_bf16_f32 v63, v97, v101
    v_mfma_f32_16x16x32_bf16 v[32:35], v[48:51], v[56:59], v[32:35]
    v_cvt_pk_bf16_f32 v66, v90, v94
    v_cvt_pk_bf16_f32 v67, v98, v102
    v_mfma_f32_16x16x32_bf16 v[36:39], v[48:51], v[60:63], v[36:39]
    v_cvt_pk_bf16_f32 v70, v91, v95
    v_cvt_pk_bf16_f32 v71, v99, v103
    v_mfma_f32_16x16x32_bf16 v[40:43], v[48:51], v[64:67], v[40:43]
    s_sub_u32 s59, s59, 1
    s_sub_u32 s63, s63, 1
    v_mfma_f32_16x16x32_bf16 v[44:47], v[48:51], v[68:71], v[44:47]
    v_add_u32 v3, 384, v3
    v_add_u32 v4, 384, v4
    s_cmp_eq_u32 s63, 0
    s_cbranch_scc0 K2_LOOP
    s_branch K2_NEXT
K2_H0:
    ds_read_b64 v[104:105], v11 offset:9216
    ds_read2_b32 v[54:55], v4 offset0:0 offset1:16
    v_lshlrev_b32 v72, 16, v136
    v_lshlrev_b32 v73, 16, v140
    v_lshlrev_b32 v74, 16, v144
    v_lshlrev_b32 v75, 16, v148
    v_lshlrev_b32 v76, 16, v137
    v_lshlrev_b32 v77, 16, v141
    v_lshlrev_b32 v78, 16, v145
    v_lshlrev_b32 v79, 16, v149
    v_lshlrev_b32 v80, 16, v138
    v_lshlrev_b32 v81, 16, v142
    v_lshlrev_b32 v82, 16, v146
    v_lshlrev_b32 v83, 16, v150
    v_lshlrev_b32 v84, 16, v139
    v_lshlrev_b32 v85, 16, v143
    v_lshlrev_b32 v86, 16, v147
    v_lshlrev_b32 v87, 16, v151
    s_waitcnt lgkmcnt(0)
    v_mfma_f32_16x16x32_bf16 v[72:75], v[104:107], v[16:19], v[72:75]
    v_mov_b32 v58, 0
    v_mov_b32 v59, 0
    v_mfma_f32_16x16x32_bf16 v[76:79], v[104:107], v[20:23], v[76:79]
    v_mov_b32 v62, 0
    v_mov_b32 v63, 0
    v_mfma_f32_16x16x32_bf16 v[80:83], v[104:107], v[24:27], v[80:83]
    v_mov_b32 v66, 0
    v_mov_b32 v67, 0
    v_mfma_f32_16x16x32_bf16 v[84:87], v[104:107], v[28:31], v[84:87]
    v_mov_b32 v70, 0
    v_mov_b32 v71, 0
    v_and_or_b32 v54, v54, s51, v6
    v_and_or_b32 v55, v55, s51, v6
    ds_read_b64_tr_b16 v[48:49], v54
    ds_read_b64_tr_b16 v[50:51], v55
    v_exp_f32 v88, v72
    v_exp_f32 v92, v73
    v_exp_f32 v96, v74
    v_exp_f32 v100, v75
    v_exp_f32 v89, v76
    v_exp_f32 v93, v77
    v_exp_f32 v97, v78
    v_exp_f32 v101, v79
    v_exp_f32 v90, v80
    v_exp_f32 v94, v81
    v_exp_f32 v98, v82
    v_exp_f32 v102, v83
    v_exp_f32 v91, v84
    v_exp_f32 v95, v85
    v_exp_f32 v99, v86
    v_exp_f32 v103, v87
    v_pk_add_f32 v[88:89], v[88:89], s[54:55]
    v_pk_add_f32 v[90:91], v[90:91], s[54:55]
    v_pk_add_f32 v[92:93], v[92:93], s[54:55]
    v_pk_add_f32 v[94:95], v[94:95], s[54:55]
    v_pk_add_f32 v[96:97], v[96:97], s[54:55]
    v_pk_add_f32 v[98:99], v[98:99], s[54:55]
    v_pk_add_f32 v[100:101], v[100:101], s[54:55]
    v_pk_add_f32 v[102:103], v[102:103], s[54:55]
    v_rcp_f32 v88, v88
    v_rcp_f32 v89, v89
    v_rcp_f32 v90, v90
    v_rcp_f32 v91, v91
    v_rcp_f32 v92, v92
    v_rcp_f32 v93, v93
    v_rcp_f32 v94, v94
    v_rcp_f32 v95, v95
    v_rcp_f32 v96, v96
    v_rcp_f32 v97, v97
    v_rcp_f32 v98, v98
    v_rcp_f32 v99, v99
    v_rcp_f32 v100, v100
    v_rcp_f32 v101, v101
    v_rcp_f32 v102, v102
    v_rcp_f32 v103, v103
    v_pk_mul_f32 v[88:89], v[88:89], v[136:137]
    v_pk_mul_f32 v[90:91], v[90:91], v[138:139]
    v_pk_mul_f32 v[92:93], v[92:93], v[140:141]
    v_pk_mul_f32 v[94:95], v[94:95], v[142:143]
    v_pk_mul_f32 v[96:97], v[96:97], v[144:145]
    v_pk_mul_f32 v[98:99], v[98:99], v[146:147]
    v_pk_mul_f32 v[100:101], v[100:101], v[148:149]
    v_pk_mul_f32 v[102:103], v[102:103], v[150:151]
    s_branch K2_HE
K2_H1:
    ds_read_b64 v[104:105], v11 offset:10240
    ds_read2_b32 v[54:55], v4 offset0:32 offset1:48
    v_lshlrev_b32 v72, 16, v168
    v_lshlrev_b32 v73, 16, v172
    v_lshlrev_b32 v74, 16, v176
    v_lshlrev_b32 v75, 16, v180
    v_lshlrev_b32 v76, 16, v169
    v_lshlrev_b32 v77, 16, v173
    v_lshlrev_b32 v78, 16, v177
    v_lshlrev_b32 v79, 16, v181
    v_lshlrev_b32 v80, 16, v170
    v_lshlrev_b32 v81, 16, v174
    v_lshlrev_b32 v82, 16, v178
    v_lshlrev_b32 v83, 16, v182
    v_lshlrev_b32 v84, 16, v171
    v_lshlrev_b32 v85, 16, v175
    v_lshlrev_b32 v86, 16, v179
    v_lshlrev_b32 v87, 16, v183
    s_waitcnt lgkmcnt(0)
    v_mfma_f32_16x16x32_bf16 v[72:75], v[104:107], v[16:19], v[72:75]
    v_mov_b32 v58, 0
    v_mov_b32 v59, 0
    v_mfma_f32_16x16x32_bf16 v[76:79], v[104:107], v[20:23], v[76:79]
    v_mov_b32 v62, 0
    v_mov_b32 v63, 0
    v_mfma_f32_16x16x32_bf16 v[80:83], v[104:107], v[24:27], v[80:83]
    v_mov_b32 v66, 0
    v_mov_b32 v67, 0
    v_mfma_f32_16x16x32_bf16 v[84:87], v[104:107], v[28:31], v[84:87]
    v_mov_b32 v70, 0
    v_mov_b32 v71, 0
    v_and_or_b32 v54, v54, s51, v6
    v_and_or_b32 v55, v55, s51, v6
    ds_read_b64_tr_b16 v[48:49], v54
    ds_read_b64_tr_b16 v[50:51], v55
    v_exp_f32 v88, v72
    v_exp_f32 v92, v73
    v_exp_f32 v96, v74
    v_exp_f32 v100, v75
    v_exp_f32 v89, v76
    v_exp_f32 v93, v77
    v_exp_f32 v97, v78
    v_exp_f32 v101, v79
    v_exp_f32 v90, v80
    v_exp_f32 v94, v81
    v_exp_f32 v98, v82
    v_exp_f32 v102, v83
    v_exp_f32 v91, v84
    v_exp_f32 v95, v85
    v_exp_f32 v99, v86
    v_exp_f32 v103, v87
    v_pk_add_f32 v[88:89], v[88:89], s[54:55]
    v_pk_add_f32 v[90:91], v[90:91], s[54:55]
    v_pk_add_f32 v[92:93], v[92:93], s[54:55]
    v_pk_add_f32 v[94:95], v[94:95], s[54:55]
    v_pk_add_f32 v[96:97], v[96:97], s[54:55]
    v_pk_add_f32 v[98:99], v[98:99], s[54:55]
    v_pk_add_f32 v[100:101], v[100:101], s[54:55]
    v_pk_add_f32 v[102:103], v[102:103], s[54:55]
    v_rcp_f32 v88, v88
    v_rcp_f32 v89, v89
    v_rcp_f32 v90, v90
    v_rcp_f32 v91, v91
    v_rcp_f32 v92, v92
    v_rcp_f32 v93, v93
    v_rcp_f32 v94, v94
    v_rcp_f32 v95, v95
    v_rcp_f32 v96, v96
    v_rcp_f32 v97, v97
    v_rcp_f32 v98, v98
    v_rcp_f32 v99, v99
    v_rcp_f32 v100, v100
    v_rcp_f32 v101, v101
    v_rcp_f32 v102, v102
    v_rcp_f32 v103, v103
    v_pk_mul_f32 v[88:89], v[88:89], v[168:169]
    v_pk_mul_f32 v[90:91], v[90:91], v[170:171]
    v_pk_mul_f32 v[92:93], v[92:93], v[172:173]
    v_pk_mul_f32 v[94:95], v[94:95], v[174:175]
    v_pk_mul_f32 v[96:97], v[96:97], v[176:177]
    v_pk_mul_f32 v[98:99], v[98:99], v[178:179]
    v_pk_mul_f32 v[100:101], v[100:101], v[180:181]
    v_pk_mul_f32 v[102:103], v[102:103], v[182:183]
    s_branch K2_HE
K2_H2:
    ds_read_b64 v[104:105], v11 offset:11264
    ds_read2_b32 v[54:55], v4 offset0:64 offset1:80
    v_lshlrev_b32 v72, 16, v200
    v_lshlrev_b32 v73, 16, v204
    v_lshlrev_b32 v74, 16, v208
    v_lshlrev_b32 v75, 16, v212
    v_lshlrev_b32 v76, 16, v201
    v_lshlrev_b32 v77, 16, v205
    v_lshlrev_b32 v78, 16, v209
    v_lshlrev_b32 v79, 16, v213
    v_lshlrev_b32 v80, 16, v202
    v_lshlrev_b32 v81, 16, v206
    v_lshlrev_b32 v82, 16, v210
    v_lshlrev_b32 v83, 16, v214
    v_lshlrev_b32 v84, 16, v203
    v_lshlrev_b32 v85, 16, v207
    v_lshlrev_b32 v86, 16, v211
    v_lshlrev_b32 v87, 16, v215
    s_waitcnt lgkmcnt(0)
    v_mfma_f32_16x16x32_bf16 v[72:75], v[104:107], v[16:19], v[72:75]
    v_mov_b32 v58, 0
    v_mov_b32 v59, 0
    v_mfma_f32_16x16x32_bf16 v[76:79], v[104:107], v[20:23], v[76:79]
    v_mov_b32 v62, 0
    v_mov_b32 v63, 0
    v_mfma_f32_16x16x32_bf16 v[80:83], v[104:107], v[24:27], v[80:83]
    v_mov_b32 v66, 0
    v_mov_b32 v67, 0
    v_mfma_f32_16x16x32_bf16 v[84:87], v[104:107], v[28:31], v[84:87]
    v_mov_b32 v70, 0
    v_mov_b32 v71, 0
    v_and_or_b32 v54, v54, s51, v6
    v_and_or_b32 v55, v55, s51, v6
    ds_read_b64_tr_b16 v[48:49], v54
    ds_read_b64_tr_b16 v[50:51], v55
    v_exp_f32 v88, v72
    v_exp_f32 v92, v73
    v_exp_f32 v96, v74
    v_exp_f32 v100, v75
    v_exp_f32 v89, v76
    v_exp_f32 v93, v77
    v_exp_f32 v97, v78
    v_exp_f32 v101, v79
    v_exp_f32 v90, v80
    v_exp_f32 v94, v81
    v_exp_f32 v98, v82
    v_exp_f32 v102, v83
    v_exp_f32 v91, v84
    v_exp_f32 v95, v85
    v_exp_f32 v99, v86
    v_exp_f32 v103, v87
    v_pk_add_f32 v[88:89], v[88:89], s[54:55]
    v_pk_add_f32 v[90:91], v[90:91], s[54:55]
    v_pk_add_f32 v[92:93], v[92:93], s[54:55]
    v_pk_add_f32 v[94:95], v[94:95], s[54:55]
    v_pk_add_f32 v[96:97], v[96:97], s[54:55]
    v_pk_add_f32 v[98:99], v[98:99], s[54:55]
    v_pk_add_f32 v[100:101], v[100:101], s[54:55]
    v_pk_add_f32 v[102:103], v[102:103], s[54:55]
    v_rcp_f32 v88, v88
    v_rcp_f32 v89, v89
    v_rcp_f32 v90, v90
    v_rcp_f32 v91, v91
    v_rcp_f32 v92, v92
    v_rcp_f32 v93, v93
    v_rcp_f32 v94, v94
    v_rcp_f32 v95, v95
    v_rcp_f32 v96, v96
    v_rcp_f32 v97, v97
    v_rcp_f32 v98, v98
    v_rcp_f32 v99, v99
    v_rcp_f32 v100, v100
    v_rcp_f32 v101, v101
    v_rcp_f32 v102, v102
    v_rcp_f32 v103, v103
    v_pk_mul_f32 v[88:89], v[88:89], v[200:201]
    v_pk_mul_f32 v[90:91], v[90:91], v[202:203]
    v_pk_mul_f32 v[92:93], v[92:93], v[204:205]
    v_pk_mul_f32 v[94:95], v[94:95], v[206:207]
    v_pk_mul_f32 v[96:97], v[96:97], v[208:209]
    v_pk_mul_f32 v[98:99], v[98:99], v[210:211]
    v_pk_mul_f32 v[100:101], v[100:101], v[212:213]
    v_pk_mul_f32 v[102:103], v[102:103], v[214:215]
K2_HE:
    s_waitcnt lgkmcnt(0)
    v_cvt_pk_bf16_f32 v56, v88, v92
    v_cvt_pk_bf16_f32 v57, v96, v100
    v_cvt_pk_bf16_f32 v60, v89, v93
    v_cvt_pk_bf16_f32 v61, v97, v101
    v_cvt_pk_bf16_f32 v64, v90, v94
    v_cvt_pk_bf16_f32 v65, v98, v102
    v_cvt_pk_bf16_f32 v68, v91, v95
    v_cvt_pk_bf16_f32 v69, v99, v103
    v_mfma_f32_16x16x32_bf16 v[32:35], v[48:51], v[56:59], v[32:35]
    v_mfma_f32_16x16x32_bf16 v[36:39], v[48:51], v[60:63], v[36:39]
    v_mfma_f32_16x16x32_bf16 v[40:43], v[48:51], v[64:67], v[40:43]
    v_mfma_f32_16x16x32_bf16 v[44:47], v[48:51], v[68:71], v[44:47]
K2_NEXT:
    s_nop 7
    s_cmp_lt_u32 s62, 5
    s_cbranch_scc1 K2_SLOW
    s_cmp_eq_u64 s[56:57], 0
    s_cbranch_scc1 K2_FINAL
    s_mov_b32 s62, 0
    s_ff1_i32_b64 s60, s[56:57]
    s_bitset0_b64 s[56:57], s60
    s_and_b32 s61, s60, 7
    s_lshl_b32 s61, s61, 3
    s_lshr_b32 s60, s60, 3
    s_add_u32 s60, s60, s61
    s_mul_i32 s61, s60, 2500
K2_SLOW:
    s_waitcnt vmcnt(0) lgkmcnt(0)
    s_mov_b32 s68, s10
    s_and_b32 s69, s11, 0xffff
    s_mov_b32 s70, 640000
    s_mov_b32 s71, 0x20000
    s_mov_b32 s72, s8
    s_and_b32 s73, s9, 0xffff
    s_mov_b32 s74, 640000
    s_mov_b32 s75, 0x20000
    s_mul_i32 s64, s62, 500
    s_add_u32 s64, s64, s61
    s_lshl_b32 s65, s64, 2
    v_lshlrev_b32 v152, 4, v7
    buffer_load_dwordx4 v[136:139], v152, s[68:71], s65 offen
    buffer_load_dwordx4 v[140:143], v152, s[68:71], s65 offen offset:1024
    buffer_load_dwordx4 v[144:147], v152, s[72:75], s65 offen
    buffer_load_dwordx4 v[148:151], v152, s[72:75], s65 offen offset:1024
    s_mov_b32 s58, 0
    s_add_u32 s62, s62, 1
    s_mul_i32 s66, s40, 10
    s_waitcnt vmcnt(0)
    v_lshlrev_b32 v153, 2, v7
    v_add_u32 v153, 0, v153
    v_mov_b32 v154, 500
    v_cmp_lt_u32 s[76:77], v153, v154
    v_subrev_u32 v154, s66, v136
    v_cmp_gt_u32 vcc, 10, v154
    s_and_b64 vcc, vcc, s[76:77]
    v_lshlrev_b32 v155, 16, v144
    v_add_lshl_u32 v156, v153, s64, 9
    v_lshl_add_u32 v156, v154, 5, v156
    v_mbcnt_lo_u32_b32 v157, vcc_lo, 0
    v_mbcnt_hi_u32_b32 v157, vcc_hi, v157
    v_add_lshl_u32 v157, v157, s58, 2
    v_add_u32 v157, s48, v157
    s_bcnt1_i32_b64 s67, vcc
    s_add_u32 s58, s58, s67
    s_mov_b64 exec, vcc
    ds_write_b32 v157, v155 offset:512
    ds_write_b32 v157, v156 offset:4864
    s_mov_b64 exec, -1
    v_lshlrev_b32 v153, 2, v7
    v_add_u32 v153, 1, v153
    v_mov_b32 v154, 500
    v_cmp_lt_u32 s[76:77], v153, v154
    v_subrev_u32 v154, s66, v137
    v_cmp_gt_u32 vcc, 10, v154
    s_and_b64 vcc, vcc, s[76:77]
    v_lshlrev_b32 v155, 16, v145
    v_add_lshl_u32 v156, v153, s64, 9
    v_lshl_add_u32 v156, v154, 5, v156
    v_mbcnt_lo_u32_b32 v157, vcc_lo, 0
    v_mbcnt_hi_u32_b32 v157, vcc_hi, v157
    v_add_lshl_u32 v157, v157, s58, 2
    v_add_u32 v157, s48, v157
    s_bcnt1_i32_b64 s67, vcc
    s_add_u32 s58, s58, s67
    s_mov_b64 exec, vcc
    ds_write_b32 v157, v155 offset:512
    ds_write_b32 v157, v156 offset:4864
    s_mov_b64 exec, -1
    v_lshlrev_b32 v153, 2, v7
    v_add_u32 v153, 2, v153
    v_mov_b32 v154, 500
    v_cmp_lt_u32 s[76:77], v153, v154
    v_subrev_u32 v154, s66, v138
    v_cmp_gt_u32 vcc, 10, v154
    s_and_b64 vcc, vcc, s[76:77]
    v_lshlrev_b32 v155, 16, v146
    v_add_lshl_u32 v156, v153, s64, 9
    v_lshl_add_u32 v156, v154, 5, v156
    v_mbcnt_lo_u32_b32 v157, vcc_lo, 0
    v_mbcnt_hi_u32_b32 v157, vcc_hi, v157
    v_add_lshl_u32 v157, v157, s58, 2
    v_add_u32 v157, s48, v157
    s_bcnt1_i32_b64 s67, vcc
    s_add_u32 s58, s58, s67
    s_mov_b64 exec, vcc
    ds_write_b32 v157, v155 offset:512
    ds_write_b32 v157, v156 offset:4864
    s_mov_b64 exec, -1
    v_lshlrev_b32 v153, 2, v7
    v_add_u32 v153, 3, v153
    v_mov_b32 v154, 500
    v_cmp_lt_u32 s[76:77], v153, v154
    v_subrev_u32 v154, s66, v139
    v_cmp_gt_u32 vcc, 10, v154
    s_and_b64 vcc, vcc, s[76:77]
    v_lshlrev_b32 v155, 16, v147
    v_add_lshl_u32 v156, v153, s64, 9
    v_lshl_add_u32 v156, v154, 5, v156
    v_mbcnt_lo_u32_b32 v157, vcc_lo, 0
    v_mbcnt_hi_u32_b32 v157, vcc_hi, v157
    v_add_lshl_u32 v157, v157, s58, 2
    v_add_u32 v157, s48, v157
    s_bcnt1_i32_b64 s67, vcc
    s_add_u32 s58, s58, s67
    s_mov_b64 exec, vcc
    ds_write_b32 v157, v155 offset:512
    ds_write_b32 v157, v156 offset:4864
    s_mov_b64 exec, -1
    v_lshlrev_b32 v153, 2, v7
    v_add_u32 v153, 256, v153
    v_mov_b32 v154, 500
    v_cmp_lt_u32 s[76:77], v153, v154
    v_subrev_u32 v154, s66, v140
    v_cmp_gt_u32 vcc, 10, v154
    s_and_b64 vcc, vcc, s[76:77]
    v_lshlrev_b32 v155, 16, v148
    v_add_lshl_u32 v156, v153, s64, 9
    v_lshl_add_u32 v156, v154, 5, v156
    v_mbcnt_lo_u32_b32 v157, vcc_lo, 0
    v_mbcnt_hi_u32_b32 v157, vcc_hi, v157
    v_add_lshl_u32 v157, v157, s58, 2
    v_add_u32 v157, s48, v157
    s_bcnt1_i32_b64 s67, vcc
    s_add_u32 s58, s58, s67
    s_mov_b64 exec, vcc
    ds_write_b32 v157, v155 offset:512
    ds_write_b32 v157, v156 offset:4864
    s_mov_b64 exec, -1
    v_lshlrev_b32 v153, 2, v7
    v_add_u32 v153, 257, v153
    v_mov_b32 v154, 500
    v_cmp_lt_u32 s[76:77], v153, v154
    v_subrev_u32 v154, s66, v141
    v_cmp_gt_u32 vcc, 10, v154
    s_and_b64 vcc, vcc, s[76:77]
    v_lshlrev_b32 v155, 16, v149
    v_add_lshl_u32 v156, v153, s64, 9
    v_lshl_add_u32 v156, v154, 5, v156
    v_mbcnt_lo_u32_b32 v157, vcc_lo, 0
    v_mbcnt_hi_u32_b32 v157, vcc_hi, v157
    v_add_lshl_u32 v157, v157, s58, 2
    v_add_u32 v157, s48, v157
    s_bcnt1_i32_b64 s67, vcc
    s_add_u32 s58, s58, s67
    s_mov_b64 exec, vcc
    ds_write_b32 v157, v155 offset:512
    ds_write_b32 v157, v156 offset:4864
    s_mov_b64 exec, -1
    v_lshlrev_b32 v153, 2, v7
    v_add_u32 v153, 258, v153
    v_mov_b32 v154, 500
    v_cmp_lt_u32 s[76:77], v153, v154
    v_subrev_u32 v154, s66, v142
    v_cmp_gt_u32 vcc, 10, v154
    s_and_b64 vcc, vcc, s[76:77]
    v_lshlrev_b32 v155, 16, v150
    v_add_lshl_u32 v156, v153, s64, 9
    v_lshl_add_u32 v156, v154, 5, v156
    v_mbcnt_lo_u32_b32 v157, vcc_lo, 0
    v_mbcnt_hi_u32_b32 v157, vcc_hi, v157
    v_add_lshl_u32 v157, v157, s58, 2
    v_add_u32 v157, s48, v157
    s_bcnt1_i32_b64 s67, vcc
    s_add_u32 s58, s58, s67
    s_mov_b64 exec, vcc
    ds_write_b32 v157, v155 offset:512
    ds_write_b32 v157, v156 offset:4864
    s_mov_b64 exec, -1
    v_lshlrev_b32 v153, 2, v7
    v_add_u32 v153, 259, v153
    v_mov_b32 v154, 500
    v_cmp_lt_u32 s[76:77], v153, v154
    v_subrev_u32 v154, s66, v143
    v_cmp_gt_u32 vcc, 10, v154
    s_and_b64 vcc, vcc, s[76:77]
    v_lshlrev_b32 v155, 16, v151
    v_add_lshl_u32 v156, v153, s64, 9
    v_lshl_add_u32 v156, v154, 5, v156
    v_mbcnt_lo_u32_b32 v157, vcc_lo, 0
    v_mbcnt_hi_u32_b32 v157, vcc_hi, v157
    v_add_lshl_u32 v157, v157, s58, 2
    v_add_u32 v157, s48, v157
    s_bcnt1_i32_b64 s67, vcc
    s_add_u32 s58, s58, s67
    s_mov_b64 exec, vcc
    ds_write_b32 v157, v155 offset:512
    ds_write_b32 v157, v156 offset:4864
    s_mov_b64 exec, -1
    s_branch K2_PROC
K2_FINAL:
    s_waitcnt vmcnt(0)
    v_lshrrev_b32 v15, 4, v7
    v_mul_u32_u24 v2, 1088, v15
    v_lshrrev_b32 v3, 2, v1
    v_add3_u32 v2, v2, v3, s48
    ds_write_b32 v2, v32 offset:512
    ds_write_b32 v2, v33 offset:784
    ds_write_b32 v2, v34 offset:1056
    ds_write_b32 v2, v35 offset:1328
    ds_write_b32 v2, v36 offset:576
    ds_write_b32 v2, v37 offset:848
    ds_write_b32 v2, v38 offset:1120
    ds_write_b32 v2, v39 offset:1392
    ds_write_b32 v2, v40 offset:640
    ds_write_b32 v2, v41 offset:912
    ds_write_b32 v2, v42 offset:1184
    ds_write_b32 v2, v43 offset:1456
    ds_write_b32 v2, v44 offset:704
    ds_write_b32 v2, v45 offset:976
    ds_write_b32 v2, v46 offset:1248
    ds_write_b32 v2, v47 offset:1520
    v_mul_u32_u24 v4, 272, v15
    v_add3_u32 v4, v4, v1, s48
    ds_read_b128 v[56:59], v4 offset:512
    ds_read_b128 v[60:63], v4 offset:1600
    ds_read_b128 v[64:67], v4 offset:2688
    v_lshlrev_b32 v6, 8, v15
    v_lshrrev_b32 v3, 1, v1
    v_add_u32 v6, v6, v3
    s_mul_i32 s44, s40, 2560
    s_add_u32 s44, s44, s45
    s_add_u32 s24, s18, s44
    s_addc_u32 s25, s19, 0
    s_and_b32 s25, s25, 0xffff
    s_mov_b32 s26, 2432
    s_mov_b32 s27, 0x20000
    s_waitcnt lgkmcnt(0)
    v_pk_mul_f32 v[72:73], v[56:57], s[52:53]
    v_pk_mul_f32 v[74:75], v[58:59], s[52:53]
    v_pk_mul_f32 v[76:77], v[60:61], s[52:53]
    v_pk_mul_f32 v[78:79], v[62:63], s[52:53]
    v_pk_mul_f32 v[80:81], v[64:65], s[52:53]
    v_pk_mul_f32 v[82:83], v[66:67], s[52:53]
    v_exp_f32 v72, v72
    v_exp_f32 v73, v73
    v_exp_f32 v74, v74
    v_exp_f32 v75, v75
    v_exp_f32 v76, v76
    v_exp_f32 v77, v77
    v_exp_f32 v78, v78
    v_exp_f32 v79, v79
    v_exp_f32 v80, v80
    v_exp_f32 v81, v81
    v_exp_f32 v82, v82
    v_exp_f32 v83, v83
    v_pk_add_f32 v[72:73], v[72:73], s[54:55]
    v_pk_add_f32 v[74:75], v[74:75], s[54:55]
    v_pk_add_f32 v[76:77], v[76:77], s[54:55]
    v_pk_add_f32 v[78:79], v[78:79], s[54:55]
    v_pk_add_f32 v[80:81], v[80:81], s[54:55]
    v_pk_add_f32 v[82:83], v[82:83], s[54:55]
    v_rcp_f32 v72, v72
    v_rcp_f32 v73, v73
    v_rcp_f32 v74, v74
    v_rcp_f32 v75, v75
    v_rcp_f32 v76, v76
    v_rcp_f32 v77, v77
    v_rcp_f32 v78, v78
    v_rcp_f32 v79, v79
    v_rcp_f32 v80, v80
    v_rcp_f32 v81, v81
    v_rcp_f32 v82, v82
    v_rcp_f32 v83, v83
    v_pk_mul_f32 v[56:57], v[56:57], v[72:73]
    v_pk_mul_f32 v[58:59], v[58:59], v[74:75]
    v_pk_mul_f32 v[60:61], v[60:61], v[76:77]
    v_pk_mul_f32 v[62:63], v[62:63], v[78:79]
    v_pk_mul_f32 v[64:65], v[64:65], v[80:81]
    v_pk_mul_f32 v[66:67], v[66:67], v[82:83]
    v_cvt_pk_bf16_f32 v88, v56, v57
    v_cvt_pk_bf16_f32 v89, v58, v59
    v_cvt_pk_bf16_f32 v90, v60, v61
    v_cvt_pk_bf16_f32 v91, v62, v63
    v_cvt_pk_bf16_f32 v92, v64, v65
    v_cvt_pk_bf16_f32 v93, v66, v67
    buffer_store_dwordx2 v[88:89], v6, s[24:27], 0 offen offset:0
    buffer_store_dwordx2 v[90:91], v6, s[24:27], 0 offen offset:1024
    buffer_store_dwordx2 v[92:93], v6, s[24:27], 0 offen offset:2048
K2_END:
    s_endpgm
.section .rodata,"a"
.p2align 6
.amdhsa_kernel prep_kernel
  .amdhsa_next_free_vgpr 110
  .amdhsa_next_free_sgpr 65
  .amdhsa_accum_offset 112
  .amdhsa_group_segment_fixed_size 0
  .amdhsa_kernarg_size 80
  .amdhsa_user_sgpr_count 2
  .amdhsa_user_sgpr_kernarg_segment_ptr 1
  .amdhsa_system_sgpr_workgroup_id_x 1
.end_amdhsa_kernel
.p2align 6
.amdhsa_kernel standalone__edge_featured_mpnn_egc__graph_kernel
  .amdhsa_next_free_vgpr 240
  .amdhsa_next_free_sgpr 78
  .amdhsa_accum_offset 240
  .amdhsa_group_segment_fixed_size 0
  .amdhsa_kernarg_size 80
  .amdhsa_user_sgpr_count 2
  .amdhsa_user_sgpr_kernarg_segment_ptr 1
  .amdhsa_system_sgpr_workgroup_id_x 1
.end_amdhsa_kernel
```
